```python
import torch

def _softmax(x, axis=-1):
    return torch.softmax(x, dim=axis)
def _gelu(x):
    return torch.nn.functional.gelu(x, approximate="tanh")
def _silu(x):
    return torch.nn.functional.silu(x)
def _sigmoid(x):
    return torch.sigmoid(x)
def _layernorm(x, axis=-1, eps=1e-5):
    m = x.mean(dim=axis, keepdim=True)
    v = x.var(dim=axis, keepdim=True, unbiased=False)
    return (x - m) / torch.sqrt(v + eps)
def _scatter_add(tgt, idx, src, axis=0):
    return tgt.clone().index_add_(axis, idx, src)
def _segment_sum(src, seg, n):
    out = torch.zeros((n,) + src.shape[1:], dtype=src.dtype)
    return out.index_add_(0, seg, src)
def _pad(x, pw):
    flat = tuple(v for pair in reversed(pw) for v in pair)
    return torch.nn.functional.pad(x, flat)

kernel_name = 'standalone__gqa_block_cached__near_ridge'

def setup_inputs():

    _w = (lambda a: (lambda t: t.to(torch.bfloat16) if t.is_floating_point() else t)(torch.as_tensor(a)))
    B, Sq, D = 16, 112, 448
    Hq, Hkv, Sk, Dh = 16, 8, 512, 256
    assert Hq % Hkv == 0, (Hq, Hkv)
    return {
        "x": _w((lambda *s: torch.randn(*s, dtype=torch.bfloat16) * 0.8)(B, Sq, D)),
        "k_cache": _w((lambda *s: torch.randn(*s, dtype=torch.bfloat16) * 0.8)(B, Hkv, Sk, Dh)),
        "v_cache": _w((lambda *s: torch.randn(*s, dtype=torch.bfloat16) * 0.05)(B, Hkv, Sk, Dh)),
        "wq": _w((lambda *s: torch.randn(*s, dtype=torch.bfloat16) * 0.8)(D, Hq * Dh) * (D ** -0.5)),
        "wo": _w((lambda *s: torch.randn(*s, dtype=torch.bfloat16) * 0.05)(Hq * Dh, D) * ((Hq * Dh) ** -0.5)),
    }

def reference(x, k_cache, v_cache, wq, wo):
    B, Sq, D = x.shape
    Hq, Dh = 16, 256
    Hkv = k_cache.shape[1]
    rep = Hq // Hkv
    q = (lambda x, *d: x.permute(*d))((x @ wq).reshape(B, Sq, Hq, Dh), 0, 2, 1, 3)
    k = (lambda x, n, axis: torch.repeat_interleave(x, n, dim=axis))(k_cache, rep, axis=1)
    v = (lambda x, n, axis: torch.repeat_interleave(x, n, dim=axis))(v_cache, rep, axis=1)
    scores = torch.einsum("bhqd,bhkd->bhqk", q, k) * (Dh ** -0.5)
    p = _softmax(scores, axis=-1)
    o = torch.einsum("bhqk,bhkd->bhqd", p, v)
    return (lambda x, *d: x.permute(*d))(o, 0, 2, 1, 3).reshape(B, Sq, Hq * Dh) @ wo
```

```asm
; @launch grid=(256,1,1) block=(256,1,1) lds=163840
.amdgcn_target "amdgcn-amd-amdhsa--gfx950"
.text
.globl standalone__gqa_block_cached__near_ridge_kernel
.p2align 8
.type standalone__gqa_block_cached__near_ridge_kernel,@function
standalone__gqa_block_cached__near_ridge_kernel:
    s_cmp_ge_u32 s2, 256
    s_cbranch_scc1 L_done
    s_load_dwordx2 s[4:5], s[0:1], 0
    s_load_dwordx2 s[16:17], s[0:1], 24
    v_lshrrev_b32 v2, 6, v0
    v_and_b32 v0, 63, v0
    s_and_b32 s61, s2, 7
    v_readfirstlane_b32 s36, v2
    s_getpc_b64 s[62:63]
L_pc:
    s_sub_u32 s62, s62, L_pc-standalone__gqa_block_cached__near_ridge_kernel
    s_subb_u32 s63, s63, 0
    s_lshr_b32 s61, s2, 3
    s_lshl2_add_u32 s61, s61, s36
    s_mul_i32 s61, s61, 3
    v_min_u32 v160, 2, v0
    v_add_u32 v160, s61, v160
    v_lshlrev_b32 v160, 7, v160
    v_min_u32 v160, L_done-standalone__gqa_block_cached__near_ridge_kernel, v160
    global_load_dword v171, v160, s[62:63]
    s_and_b32 s61, s2, 7
    s_lshr_b32 s62, s2, 3
    s_lshr_b32 s49, s62, 1
    s_and_b32 s62, s62, 1
    s_lshl1_add_u32 s50, s61, s62
    s_add_u32 s51, s61, s49
    s_and_b32 s51, s51, 3
    s_lshl_b32 s51, s51, 1
    s_mov_b32 s6, 1605632
    s_mov_b32 s7, 0x20000
    s_mov_b32 s18, 3670016
    s_mov_b32 s19, 0x20000
    s_mov_b32 s47, 0
    s_mul_i32 s37, s36, 24576
    s_mul_i32 s38, s36, 3584
    s_add_u32 s38, s38, 98304
    s_mul_i32 s39, s49, 100352
    s_lshl2_add_u32 s40, s50, s36
    s_lshl_b32 s40, s40, 7
L_restart:
    s_lshl_b32 s53, s51, 7
    v_lshrrev_b32 v2, 3, v0
    v_and_b32 v3, 7, v0
    s_mul_i32 s61, s36, 28
    v_add_u32 v162, s61, v2
    v_mul_u32_u24 v163, 896, v162
    v_bfe_u32 v161, v162, 1, 3
    v_xor_b32 v161, v161, v3
    v_lshl_add_u32 v144, v161, 4, v163
    v_add_u32 v160, 7, v162
    v_bfe_u32 v161, v160, 1, 3
    v_xor_b32 v161, v161, v3
    v_lshl_add_u32 v145, v161, 4, v163
    v_add_u32 v145, 5376, v145
    v_add_u32 v160, 14, v162
    v_bfe_u32 v161, v160, 1, 3
    v_xor_b32 v161, v161, v3
    v_lshl_add_u32 v146, v161, 4, v163
    v_add_u32 v146, 10752, v146
    v_add_u32 v160, 21, v162
    v_bfe_u32 v161, v160, 1, 3
    v_xor_b32 v161, v161, v3
    v_lshl_add_u32 v147, v161, 4, v163
    v_add_u32 v147, 16128, v147
    v_and_b32 v160, 2, v2
    v_xor_b32 v160, v160, v3
    v_lshlrev_b32 v161, 13, v2
    v_lshl_add_u32 v148, v160, 4, v161
    v_xor_b32 v160, 64, v148
    v_add_u32 v149, 64512, v160
    v_add_u32 v150, 129024, v148
    v_add_u32 v151, 193536, v160
    s_waitcnt lgkmcnt(0)
    s_add_u32 m0, s38, 0
    s_add_u32 s45, s39, s53
    buffer_load_dwordx4 v144, s[4:7], s45 offen offset:0 lds
    buffer_load_dwordx4 v145, s[4:7], s45 offen offset:896 lds
    buffer_load_dwordx4 v146, s[4:7], s45 offen offset:1792 lds
    buffer_load_dwordx4 v147, s[4:7], s45 offen offset:2688 lds
    s_add_u32 m0, s37, 0
    s_lshl_b32 s45, s53, 12
    s_add_u32 s45, s45, s40
    buffer_load_dwordx4 v148, s[16:19], s45 offen offset:0 lds
    buffer_load_dwordx4 v149, s[16:19], s45 offen offset:1024 lds
    buffer_load_dwordx4 v150, s[16:19], s45 offen offset:2048 lds
    buffer_load_dwordx4 v151, s[16:19], s45 offen offset:3072 lds
    s_add_u32 m0, s37, 4096
    s_add_u32 s45, s45, 262144
    buffer_load_dwordx4 v148, s[16:19], s45 offen offset:0 lds
    buffer_load_dwordx4 v149, s[16:19], s45 offen offset:1024 lds
    buffer_load_dwordx4 v150, s[16:19], s45 offen offset:2048 lds
    buffer_load_dwordx4 v151, s[16:19], s45 offen offset:3072 lds
    s_load_dwordx2 s[8:9], s[0:1], 8
    s_load_dwordx2 s[12:13], s[0:1], 16
    s_load_dwordx2 s[20:21], s[0:1], 32
    s_load_dwordx2 s[24:25], s[0:1], 40
    s_load_dwordx2 s[28:29], s[0:1], 48
    s_load_dwordx2 s[32:33], s[0:1], 56
    s_add_u32 s54, s53, 128
    s_cmp_eq_u32 s54, 896
    s_cselect_b32 s54, 0, s54
    s_add_u32 s55, s54, 128
    s_cmp_eq_u32 s55, 896
    s_cselect_b32 s55, 0, s55
    s_add_u32 s56, s55, 128
    s_cmp_eq_u32 s56, 896
    s_cselect_b32 s56, 0, s56
    s_add_u32 s57, s56, 128
    s_cmp_eq_u32 s57, 896
    s_cselect_b32 s57, 0, s57
    s_add_u32 s58, s57, 128
    s_cmp_eq_u32 s58, 896
    s_cselect_b32 s58, 0, s58
    s_add_u32 s59, s58, 128
    s_cmp_eq_u32 s59, 896
    s_cselect_b32 s59, 0, s59
    s_mov_b32 s10, 33554432
    s_mov_b32 s11, 0x20000
    s_mov_b32 s14, 33554432
    s_mov_b32 s15, 0x20000
    s_mov_b32 s22, 3670016
    s_mov_b32 s23, 0x20000
    s_mov_b32 s26, 1605632
    s_mov_b32 s27, 0x20000
    s_mov_b32 s30, 256
    s_mov_b32 s31, 0x20000
    s_mov_b32 s34, 268435456
    s_mov_b32 s35, 0x20000
    v_and_b32 v160, 15, v0
    v_lshrrev_b32 v161, 4, v0
    v_bfe_u32 v162, v0, 2, 2
    v_and_b32 v163, 3, v0
    v_lshlrev_b32 v163, 3, v163
    v_lshlrev_b32 v27, 4, v0
    v_add_u32 v20, 98304, v27
    v_lshrrev_b32 v164, 1, v160
    v_xor_b32 v164, v164, v161
    v_lshlrev_b32 v164, 4, v164
    v_lshlrev_b32 v165, 7, v160
    v_add_u32 v164, v164, v165
    v_xor_b32 v165, 64, v164
    v_add_u32 v152, 98304, v164
    v_add_u32 v153, 98304, v165
    v_lshlrev_b32 v164, 3, v161
    v_add_u32 v164, v164, v162
    v_lshlrev_b32 v164, 7, v164
    v_lshrrev_b32 v165, 1, v162
    v_and_b32 v166, 1, v161
    v_lshlrev_b32 v166, 1, v166
    v_or_b32 v165, v165, v166
    v_lshlrev_b32 v165, 5, v165
    v_lshlrev_b32 v167, 1, v163
    v_xor_b32 v165, v165, v167
    v_add3_u32 v154, v164, v165, s37
    v_xor_b32 v155, 8, v154
    v_xor_b32 v156, 64, v154
    v_xor_b32 v157, 72, v154
    s_waitcnt lgkmcnt(0)
    s_add_u32 m0, s38, 14464
    s_add_u32 s45, s39, s54
    buffer_load_dwordx4 v144, s[4:7], s45 offen offset:0 lds
    buffer_load_dwordx4 v145, s[4:7], s45 offen offset:896 lds
    buffer_load_dwordx4 v146, s[4:7], s45 offen offset:1792 lds
    buffer_load_dwordx4 v147, s[4:7], s45 offen offset:2688 lds
    s_add_u32 m0, s37, 8192
    s_lshl_b32 s45, s54, 12
    s_add_u32 s45, s45, s40
    buffer_load_dwordx4 v148, s[16:19], s45 offen offset:0 lds
    buffer_load_dwordx4 v149, s[16:19], s45 offen offset:1024 lds
    buffer_load_dwordx4 v150, s[16:19], s45 offen offset:2048 lds
    buffer_load_dwordx4 v151, s[16:19], s45 offen offset:3072 lds
    s_waitcnt vmcnt(12)
    s_barrier
    ds_read_b64_tr_b16 a[224:225], v154 offset:0
    ds_read_b128 a[0:3], v152 offset:0
    ds_read_b64_tr_b16 a[226:227], v154 offset:512
    ds_read_b128 a[4:7], v152 offset:2048
    ds_read_b64_tr_b16 a[228:229], v155 offset:0
    ds_read_b128 a[8:11], v152 offset:4096
    ds_read_b64_tr_b16 a[230:231], v155 offset:512
    ds_read_b128 a[12:15], v152 offset:6144
    ds_read_b64_tr_b16 a[232:233], v156 offset:0
    ds_read_b128 a[16:19], v152 offset:8192
    ds_read_b64_tr_b16 a[234:235], v156 offset:512
    ds_read_b128 a[20:23], v152 offset:10240
    ds_read_b64_tr_b16 a[236:237], v157 offset:0
    ds_read_b128 a[24:27], v152 offset:12288
    ds_read_b64_tr_b16 a[238:239], v157 offset:512
    s_waitcnt lgkmcnt(0)
    v_mfma_f32_16x16x32_bf16 v[32:35], a[224:227], a[0:3], 0
    s_waitcnt vmcnt(8)
    s_add_u32 m0, s37, 12288
    s_add_u32 s45, s45, 262144
    v_mfma_f32_16x16x32_bf16 v[36:39], a[228:231], a[0:3], 0
    buffer_load_dwordx4 v148, s[16:19], s45 offen offset:0 lds
    v_mfma_f32_16x16x32_bf16 v[40:43], a[232:235], a[0:3], 0
    buffer_load_dwordx4 v149, s[16:19], s45 offen offset:1024 lds
    v_mfma_f32_16x16x32_bf16 v[44:47], a[236:239], a[0:3], 0
    buffer_load_dwordx4 v150, s[16:19], s45 offen offset:2048 lds
    v_mfma_f32_16x16x32_bf16 v[48:51], a[224:227], a[4:7], 0
    buffer_load_dwordx4 v151, s[16:19], s45 offen offset:3072 lds
    v_mfma_f32_16x16x32_bf16 v[52:55], a[228:231], a[4:7], 0
    s_add_u32 m0, s38, 28928
    s_add_u32 s45, s39, s55
    ds_read_b64_tr_b16 a[240:241], v154 offset:4096
    v_mfma_f32_16x16x32_bf16 v[56:59], a[232:235], a[4:7], 0
    buffer_load_dwordx4 v144, s[4:7], s45 offen offset:0 lds
    v_mfma_f32_16x16x32_bf16 v[60:63], a[236:239], a[4:7], 0
    ds_read_b128 a[28:31], v153 offset:0
    v_mfma_f32_16x16x32_bf16 v[64:67], a[224:227], a[8:11], 0
    ds_read_b64_tr_b16 a[242:243], v154 offset:4608
    v_mfma_f32_16x16x32_bf16 v[68:71], a[228:231], a[8:11], 0
    ds_read_b128 a[32:35], v153 offset:2048
    v_mfma_f32_16x16x32_bf16 v[72:75], a[232:235], a[8:11], 0
    ds_read_b64_tr_b16 a[244:245], v155 offset:4096
    v_mfma_f32_16x16x32_bf16 v[76:79], a[236:239], a[8:11], 0
    buffer_load_dwordx4 v145, s[4:7], s45 offen offset:896 lds
    v_mfma_f32_16x16x32_bf16 v[80:83], a[224:227], a[12:15], 0
    ds_read_b128 a[36:39], v153 offset:4096
    v_mfma_f32_16x16x32_bf16 v[84:87], a[228:231], a[12:15], 0
    ds_read_b64_tr_b16 a[246:247], v155 offset:4608
    v_mfma_f32_16x16x32_bf16 v[88:91], a[232:235], a[12:15], 0
    ds_read_b128 a[40:43], v153 offset:6144
    v_mfma_f32_16x16x32_bf16 v[92:95], a[236:239], a[12:15], 0
    ds_read_b64_tr_b16 a[248:249], v156 offset:4096
    v_mfma_f32_16x16x32_bf16 v[96:99], a[224:227], a[16:19], 0
    ds_read_b128 a[44:47], v153 offset:8192
    v_mfma_f32_16x16x32_bf16 v[100:103], a[228:231], a[16:19], 0
    buffer_load_dwordx4 v146, s[4:7], s45 offen offset:1792 lds
    v_mfma_f32_16x16x32_bf16 v[104:107], a[232:235], a[16:19], 0
    ds_read_b64_tr_b16 a[250:251], v156 offset:4608
    v_mfma_f32_16x16x32_bf16 v[108:111], a[236:239], a[16:19], 0
    ds_read_b128 a[48:51], v153 offset:10240
    v_mfma_f32_16x16x32_bf16 v[112:115], a[224:227], a[20:23], 0
    ds_read_b64_tr_b16 a[252:253], v157 offset:4096
    v_mfma_f32_16x16x32_bf16 v[116:119], a[228:231], a[20:23], 0
    ds_read_b128 a[52:55], v153 offset:12288
    ds_read_b64_tr_b16 a[254:255], v157 offset:4608
    v_mfma_f32_16x16x32_bf16 v[120:123], a[232:235], a[20:23], 0
    buffer_load_dwordx4 v147, s[4:7], s45 offen offset:2688 lds
    v_mfma_f32_16x16x32_bf16 v[124:127], a[236:239], a[20:23], 0
    v_mfma_f32_16x16x32_bf16 v[128:131], a[224:227], a[24:27], 0
    s_add_u32 m0, s37, 16384
    s_lshl_b32 s45, s55, 12
    s_add_u32 s45, s45, s40
    v_mfma_f32_16x16x32_bf16 v[132:135], a[228:231], a[24:27], 0
    v_mfma_f32_16x16x32_bf16 v[136:139], a[232:235], a[24:27], 0
    v_mfma_f32_16x16x32_bf16 v[140:143], a[236:239], a[24:27], 0
    s_waitcnt lgkmcnt(0)
    v_mfma_f32_16x16x32_bf16 v[32:35], a[240:243], a[28:31], v[32:35]
    s_waitcnt vmcnt(8)
    s_barrier
    ds_read_b64_tr_b16 a[224:225], v154 offset:8192
    v_mfma_f32_16x16x32_bf16 v[36:39], a[244:247], a[28:31], v[36:39]
    buffer_load_dwordx4 v148, s[16:19], s45 offen offset:0 lds
    v_mfma_f32_16x16x32_bf16 v[40:43], a[248:251], a[28:31], v[40:43]
    ds_read_b128 a[0:3], v152 offset:14464
    v_mfma_f32_16x16x32_bf16 v[44:47], a[252:255], a[28:31], v[44:47]
    ds_read_b64_tr_b16 a[226:227], v154 offset:8704
    v_mfma_f32_16x16x32_bf16 v[48:51], a[240:243], a[32:35], v[48:51]
    ds_read_b128 a[4:7], v152 offset:16512
    v_mfma_f32_16x16x32_bf16 v[52:55], a[244:247], a[32:35], v[52:55]
    buffer_load_dwordx4 v149, s[16:19], s45 offen offset:1024 lds
    v_mfma_f32_16x16x32_bf16 v[56:59], a[248:251], a[32:35], v[56:59]
    ds_read_b64_tr_b16 a[228:229], v155 offset:8192
    v_mfma_f32_16x16x32_bf16 v[60:63], a[252:255], a[32:35], v[60:63]
    ds_read_b128 a[8:11], v152 offset:18560
    v_mfma_f32_16x16x32_bf16 v[64:67], a[240:243], a[36:39], v[64:67]
    ds_read_b64_tr_b16 a[230:231], v155 offset:8704
    v_mfma_f32_16x16x32_bf16 v[68:71], a[244:247], a[36:39], v[68:71]
    ds_read_b128 a[12:15], v152 offset:20608
    v_mfma_f32_16x16x32_bf16 v[72:75], a[248:251], a[36:39], v[72:75]
    ds_read_b64_tr_b16 a[232:233], v156 offset:8192
    v_mfma_f32_16x16x32_bf16 v[76:79], a[252:255], a[36:39], v[76:79]
    buffer_load_dwordx4 v150, s[16:19], s45 offen offset:2048 lds
    v_mfma_f32_16x16x32_bf16 v[80:83], a[240:243], a[40:43], v[80:83]
    s_lshl4_add_u32 s61, s49, s50
    s_mul_i32 s44, s61, 100352
    s_mul_i32 s60, s36, 3584
    s_add_u32 s44, s44, s60
    s_lshr_b32 s60, s61, 1
    s_lshl_b32 s60, s60, 18
    s_lshl_b32 s61, s36, 7
    s_add_u32 s42, s60, s61
    s_lshl_b32 s61, s36, 14
    s_add_u32 s41, s60, s61
    s_lshl2_add_u32 s61, s50, s36
    s_mul_i32 s43, s61, 57344
    s_mov_b32 s48, 0x3db8aa3b
    s_mov_b32 s64, s49
    s_mul_i32 s60, s64, 37
    s_lshr_b32 s60, s60, 8
    s_mul_i32 s60, s60, 7
    v_mfma_f32_16x16x32_bf16 v[84:87], a[244:247], a[40:43], v[84:87]
    ds_read_b128 a[16:19], v152 offset:22656
    v_mfma_f32_16x16x32_bf16 v[88:91], a[248:251], a[40:43], v[88:91]
    ds_read_b64_tr_b16 a[234:235], v156 offset:8704
    v_mfma_f32_16x16x32_bf16 v[92:95], a[252:255], a[40:43], v[92:95]
    ds_read_b128 a[20:23], v152 offset:24704
    v_mfma_f32_16x16x32_bf16 v[96:99], a[240:243], a[44:47], v[96:99]
    buffer_load_dwordx4 v151, s[16:19], s45 offen offset:3072 lds
    v_mfma_f32_16x16x32_bf16 v[100:103], a[244:247], a[44:47], v[100:103]
    ds_read_b64_tr_b16 a[236:237], v157 offset:8192
    v_mfma_f32_16x16x32_bf16 v[104:107], a[248:251], a[44:47], v[104:107]
    s_add_u32 m0, s37, 20480
    ds_read_b128 a[24:27], v152 offset:26752
    s_add_u32 s45, s45, 262144
    v_mfma_f32_16x16x32_bf16 v[108:111], a[252:255], a[44:47], v[108:111]
    ds_read_b64_tr_b16 a[238:239], v157 offset:8704
    v_mfma_f32_16x16x32_bf16 v[112:115], a[240:243], a[48:51], v[112:115]
    v_mfma_f32_16x16x32_bf16 v[116:119], a[244:247], a[48:51], v[116:119]
    v_mfma_f32_16x16x32_bf16 v[120:123], a[248:251], a[48:51], v[120:123]
    buffer_load_dwordx4 v148, s[16:19], s45 offen offset:0 lds
    v_mfma_f32_16x16x32_bf16 v[124:127], a[252:255], a[48:51], v[124:127]
    v_mfma_f32_16x16x32_bf16 v[128:131], a[240:243], a[52:55], v[128:131]
    s_sub_u32 s64, s64, s60
    v_lshrrev_b32 v164, 1, v161
    v_or_b32 v164, v164, v166
    v_lshlrev_b32 v164, 4, v164
    v_add_u32 v164, v164, v160
    v_lshlrev_b32 v164, 4, v164
    s_mul_i32 s61, s36, 14336
    s_add_u32 s62, s61, 98304
    v_add_u32 v158, s62, v164
    v_add_u32 v22, s61, v20
    s_lshr_b32 s61, s61, 1
    v_add_u32 v21, s61, v20
    v_add_u32 v164, 0, v161
    v_xor_b32 v165, v164, v160
    v_lshlrev_b32 v165, 4, v165
    v_lshlrev_b32 v164, 9, v161
    v_add_u32 v164, 0, v164
    v_mfma_f32_16x16x32_bf16 v[132:135], a[244:247], a[52:55], v[132:135]
    v_mfma_f32_16x16x32_bf16 v[136:139], a[248:251], a[52:55], v[136:139]
    v_mfma_f32_16x16x32_bf16 v[140:143], a[252:255], a[52:55], v[140:143]
    s_waitcnt lgkmcnt(0)
    v_mfma_f32_16x16x32_bf16 v[32:35], a[224:227], a[0:3], v[32:35]
    s_waitcnt vmcnt(9)
    ds_read_b64_tr_b16 a[240:241], v154 offset:12288
    v_mfma_f32_16x16x32_bf16 v[36:39], a[228:231], a[0:3], v[36:39]
    buffer_load_dwordx4 v149, s[16:19], s45 offen offset:1024 lds
    v_mfma_f32_16x16x32_bf16 v[40:43], a[232:235], a[0:3], v[40:43]
    ds_read_b128 a[28:31], v153 offset:14464
    v_mfma_f32_16x16x32_bf16 v[44:47], a[236:239], a[0:3], v[44:47]
    ds_read_b64_tr_b16 a[242:243], v154 offset:12800
    v_mfma_f32_16x16x32_bf16 v[48:51], a[224:227], a[4:7], v[48:51]
    ds_read_b128 a[32:35], v153 offset:16512
    v_mfma_f32_16x16x32_bf16 v[52:55], a[228:231], a[4:7], v[52:55]
    buffer_load_dwordx4 v150, s[16:19], s45 offen offset:2048 lds
    v_mfma_f32_16x16x32_bf16 v[56:59], a[232:235], a[4:7], v[56:59]
    ds_read_b64_tr_b16 a[244:245], v155 offset:12288
    v_mfma_f32_16x16x32_bf16 v[60:63], a[236:239], a[4:7], v[60:63]
    ds_read_b128 a[36:39], v153 offset:18560
    v_mfma_f32_16x16x32_bf16 v[64:67], a[224:227], a[8:11], v[64:67]
    v_add_u32 v4, v164, v165
    v_add_u32 v164, 4, v161
    v_xor_b32 v165, v164, v160
    v_lshlrev_b32 v165, 4, v165
    v_lshlrev_b32 v164, 9, v161
    v_add_u32 v164, 1024, v164
    v_add_u32 v5, v164, v165
    v_add_u32 v164, 8, v161
    v_xor_b32 v165, v164, v160
    v_lshlrev_b32 v165, 4, v165
    v_lshlrev_b32 v164, 9, v161
    v_add_u32 v164, 2048, v164
    v_add_u32 v6, v164, v165
    v_add_u32 v164, 12, v161
    v_xor_b32 v165, v164, v160
    v_lshlrev_b32 v165, 4, v165
    v_lshlrev_b32 v164, 9, v161
    v_mfma_f32_16x16x32_bf16 v[68:71], a[228:231], a[8:11], v[68:71]
    ds_read_b64_tr_b16 a[246:247], v155 offset:12800
    v_mfma_f32_16x16x32_bf16 v[72:75], a[232:235], a[8:11], v[72:75]
    buffer_load_dwordx4 v151, s[16:19], s45 offen offset:3072 lds
    v_mfma_f32_16x16x32_bf16 v[76:79], a[236:239], a[8:11], v[76:79]
    ds_read_b128 a[40:43], v153 offset:20608
    v_mfma_f32_16x16x32_bf16 v[80:83], a[224:227], a[12:15], v[80:83]
    s_add_u32 m0, s38, 43392
    s_add_u32 s45, s39, s56
    ds_read_b64_tr_b16 a[248:249], v156 offset:12288
    v_mfma_f32_16x16x32_bf16 v[84:87], a[228:231], a[12:15], v[84:87]
    ds_read_b128 a[44:47], v153 offset:22656
    v_mfma_f32_16x16x32_bf16 v[88:91], a[232:235], a[12:15], v[88:91]
    ds_read_b64_tr_b16 a[250:251], v156 offset:12800
    v_mfma_f32_16x16x32_bf16 v[92:95], a[236:239], a[12:15], v[92:95]
    ds_read_b128 a[48:51], v153 offset:24704
    v_mfma_f32_16x16x32_bf16 v[96:99], a[224:227], a[16:19], v[96:99]
    buffer_load_dwordx4 v144, s[4:7], s45 offen offset:0 lds
    v_mfma_f32_16x16x32_bf16 v[100:103], a[228:231], a[16:19], v[100:103]
    ds_read_b64_tr_b16 a[252:253], v157 offset:12288
    v_mfma_f32_16x16x32_bf16 v[104:107], a[232:235], a[16:19], v[104:107]
    ds_read_b128 a[52:55], v153 offset:26752
    v_mfma_f32_16x16x32_bf16 v[108:111], a[236:239], a[16:19], v[108:111]
    ds_read_b64_tr_b16 a[254:255], v157 offset:12800
    v_mfma_f32_16x16x32_bf16 v[112:115], a[224:227], a[20:23], v[112:115]
    v_add_u32 v164, 3072, v164
    v_add_u32 v7, v164, v165
    v_xor_b32 v164, v161, v160
    v_lshlrev_b32 v164, 4, v164
    v_lshlrev_b32 v165, 8, v160
    v_add3_u32 v8, v164, v165, s37
    v_xor_b32 v9, 64, v8
    v_xor_b32 v10, 128, v8
    v_xor_b32 v11, 192, v8
    v_and_b32 v164, 6, v2
    v_xor_b32 v164, v164, v3
    v_lshlrev_b32 v164, 4, v164
    v_lshlrev_b32 v165, 9, v2
    v_add_u32 v12, v164, v165
    v_add_u32 v13, 3072, v12
    v_add_u32 v14, 6144, v12
    v_add_u32 v15, 9216, v12
    v_mfma_f32_16x16x32_bf16 v[116:119], a[228:231], a[20:23], v[116:119]
    buffer_load_dwordx4 v145, s[4:7], s45 offen offset:896 lds
    v_mfma_f32_16x16x32_bf16 v[120:123], a[232:235], a[20:23], v[120:123]
    v_mfma_f32_16x16x32_bf16 v[124:127], a[236:239], a[20:23], v[124:127]
    v_mfma_f32_16x16x32_bf16 v[128:131], a[224:227], a[24:27], v[128:131]
    v_mfma_f32_16x16x32_bf16 v[132:135], a[228:231], a[24:27], v[132:135]
    v_mfma_f32_16x16x32_bf16 v[136:139], a[232:235], a[24:27], v[136:139]
    v_mfma_f32_16x16x32_bf16 v[140:143], a[236:239], a[24:27], v[140:143]
    s_waitcnt lgkmcnt(0)
    v_mfma_f32_16x16x32_bf16 v[32:35], a[240:243], a[28:31], v[32:35]
    s_waitcnt vmcnt(6)
    s_barrier
    ds_read_b64_tr_b16 a[224:225], v154 offset:16384
    v_mfma_f32_16x16x32_bf16 v[36:39], a[244:247], a[28:31], v[36:39]
    buffer_load_dwordx4 v146, s[4:7], s45 offen offset:1792 lds
    v_mfma_f32_16x16x32_bf16 v[40:43], a[248:251], a[28:31], v[40:43]
    ds_read_b128 a[0:3], v152 offset:28928
    v_mfma_f32_16x16x32_bf16 v[44:47], a[252:255], a[28:31], v[44:47]
    ds_read_b64_tr_b16 a[226:227], v154 offset:16896
    v_mfma_f32_16x16x32_bf16 v[48:51], a[240:243], a[32:35], v[48:51]
    v_mul_u32_u24 v165, 896, v2
    v_add_u32 v25, v164, v165
    v_lshlrev_b32 v164, 2, v161
    v_add_u32 v164, v164, v162
    v_bfe_u32 v165, v164, 1, 2
    v_lshlrev_b32 v165, 5, v165
    v_lshlrev_b32 v164, 7, v164
    v_add3_u32 v164, v164, v165, v163
    v_add_u32 v16, s37, v164
    v_xor_b32 v17, 32, v16
    v_xor_b32 v18, 64, v16
    v_xor_b32 v19, 96, v16
    s_lshl_b32 s61, s36, 5
    v_xor_b32 v26, s61, v164
    v_lshlrev_b32 v164, 4, v160
    v_add_u32 v24, 156160, v164
    s_lshl_b32 s61, s36, 2
    v_mfma_f32_16x16x32_bf16 v[52:55], a[244:247], a[32:35], v[52:55]
    buffer_load_dwordx4 v147, s[4:7], s45 offen offset:2688 lds
    v_mfma_f32_16x16x32_bf16 v[56:59], a[248:251], a[32:35], v[56:59]
    s_add_u32 m0, s37, 0
    s_lshl_b32 s45, s56, 12
    s_add_u32 s45, s45, s40
    v_mfma_f32_16x16x32_bf16 v[60:63], a[252:255], a[32:35], v[60:63]
    ds_read_b128 a[4:7], v152 offset:30976
    v_mfma_f32_16x16x32_bf16 v[64:67], a[240:243], a[36:39], v[64:67]
    ds_read_b64_tr_b16 a[228:229], v155 offset:16384
    v_mfma_f32_16x16x32_bf16 v[68:71], a[244:247], a[36:39], v[68:71]
    ds_read_b128 a[8:11], v152 offset:33024
    v_mfma_f32_16x16x32_bf16 v[72:75], a[248:251], a[36:39], v[72:75]
    buffer_load_dwordx4 v148, s[16:19], s45 offen offset:0 lds
    v_mfma_f32_16x16x32_bf16 v[76:79], a[252:255], a[36:39], v[76:79]
    ds_read_b64_tr_b16 a[230:231], v155 offset:16896
    v_mfma_f32_16x16x32_bf16 v[80:83], a[240:243], a[40:43], v[80:83]
    ds_read_b128 a[12:15], v152 offset:35072
    v_mfma_f32_16x16x32_bf16 v[84:87], a[244:247], a[40:43], v[84:87]
    ds_read_b64_tr_b16 a[232:233], v156 offset:16384
    v_mfma_f32_16x16x32_bf16 v[88:91], a[248:251], a[40:43], v[88:91]
    ds_read_b128 a[16:19], v152 offset:37120
    v_mfma_f32_16x16x32_bf16 v[92:95], a[252:255], a[40:43], v[92:95]
    buffer_load_dwordx4 v149, s[16:19], s45 offen offset:1024 lds
    v_mfma_f32_16x16x32_bf16 v[96:99], a[240:243], a[44:47], v[96:99]
    v_add_u32 v23, s61, v24
    v_mov_b32 v165, 0x3f803f80
    v_cmp_eq_u32 vcc, 0, v160
    s_nop 1
    v_cndmask_b32 v228, 0, v165, vcc
    v_cndmask_b32 v229, 0, v165, vcc
    v_cndmask_b32 v230, 0, v165, vcc
    v_cndmask_b32 v231, 0, v165, vcc
    v_cmp_eq_u32 vcc, 1, v160
    s_nop 1
    v_cndmask_b32 v232, 0, v165, vcc
    v_cndmask_b32 v233, 0, v165, vcc
    v_cndmask_b32 v234, 0, v165, vcc
    v_cndmask_b32 v235, 0, v165, vcc
    v_cmp_eq_u32 vcc, 2, v160
    s_nop 1
    v_cndmask_b32 v236, 0, v165, vcc
    v_cndmask_b32 v237, 0, v165, vcc
    v_cndmask_b32 v238, 0, v165, vcc
    v_cndmask_b32 v239, 0, v165, vcc
    v_mfma_f32_16x16x32_bf16 v[100:103], a[244:247], a[44:47], v[100:103]
    ds_read_b64_tr_b16 a[234:235], v156 offset:16896
    v_mfma_f32_16x16x32_bf16 v[104:107], a[248:251], a[44:47], v[104:107]
    ds_read_b128 a[20:23], v152 offset:39168
    v_mfma_f32_16x16x32_bf16 v[108:111], a[252:255], a[44:47], v[108:111]
    ds_read_b64_tr_b16 a[236:237], v157 offset:16384
    v_mfma_f32_16x16x32_bf16 v[112:115], a[240:243], a[48:51], v[112:115]
    ds_read_b128 a[24:27], v152 offset:41216
    v_mfma_f32_16x16x32_bf16 v[116:119], a[244:247], a[48:51], v[116:119]
    ds_read_b64_tr_b16 a[238:239], v157 offset:16896
    v_mfma_f32_16x16x32_bf16 v[120:123], a[248:251], a[48:51], v[120:123]
    buffer_load_dwordx4 v150, s[16:19], s45 offen offset:2048 lds
    v_mfma_f32_16x16x32_bf16 v[124:127], a[252:255], a[48:51], v[124:127]
    v_mfma_f32_16x16x32_bf16 v[128:131], a[240:243], a[52:55], v[128:131]
    v_mfma_f32_16x16x32_bf16 v[132:135], a[244:247], a[52:55], v[132:135]
    v_mfma_f32_16x16x32_bf16 v[136:139], a[248:251], a[52:55], v[136:139]
    buffer_load_dwordx4 v151, s[16:19], s45 offen offset:3072 lds
    v_mfma_f32_16x16x32_bf16 v[140:143], a[252:255], a[52:55], v[140:143]
    s_waitcnt lgkmcnt(0)
    v_mfma_f32_16x16x32_bf16 v[32:35], a[224:227], a[0:3], v[32:35]
    s_waitcnt vmcnt(8)
    v_cmp_eq_u32 vcc, 3, v160
    s_nop 1
    v_cndmask_b32 v240, 0, v165, vcc
    v_cndmask_b32 v241, 0, v165, vcc
    v_cndmask_b32 v242, 0, v165, vcc
    v_cndmask_b32 v243, 0, v165, vcc
    v_cmp_eq_u32 vcc, 4, v160
    s_nop 1
    v_cndmask_b32 v244, 0, v165, vcc
    v_cndmask_b32 v245, 0, v165, vcc
    v_cndmask_b32 v246, 0, v165, vcc
    v_cndmask_b32 v247, 0, v165, vcc
    v_cmp_eq_u32 vcc, 5, v160
    s_nop 1
    v_cndmask_b32 v248, 0, v165, vcc
    v_cndmask_b32 v249, 0, v165, vcc
    v_cndmask_b32 v250, 0, v165, vcc
    v_cndmask_b32 v251, 0, v165, vcc
    v_cmp_eq_u32 vcc, 6, v160
    s_nop 1
    v_cndmask_b32 v252, 0, v165, vcc
    v_mfma_f32_16x16x32_bf16 v[36:39], a[228:231], a[0:3], v[36:39]
    s_add_u32 m0, s37, 4096
    s_add_u32 s45, s45, 262144
    ds_read_b64_tr_b16 a[240:241], v154 offset:20480
    v_mfma_f32_16x16x32_bf16 v[40:43], a[232:235], a[0:3], v[40:43]
    ds_read_b128 a[28:31], v153 offset:28928
    v_mfma_f32_16x16x32_bf16 v[44:47], a[236:239], a[0:3], v[44:47]
    ds_read_b64_tr_b16 a[242:243], v154 offset:20992
    v_mfma_f32_16x16x32_bf16 v[48:51], a[224:227], a[4:7], v[48:51]
    buffer_load_dwordx4 v148, s[16:19], s45 offen offset:0 lds
    v_mfma_f32_16x16x32_bf16 v[52:55], a[228:231], a[4:7], v[52:55]
    ds_read_b128 a[32:35], v153 offset:30976
    v_mfma_f32_16x16x32_bf16 v[56:59], a[232:235], a[4:7], v[56:59]
    ds_read_b64_tr_b16 a[244:245], v155 offset:20480
    v_mfma_f32_16x16x32_bf16 v[60:63], a[236:239], a[4:7], v[60:63]
    ds_read_b128 a[36:39], v153 offset:33024
    v_mfma_f32_16x16x32_bf16 v[64:67], a[224:227], a[8:11], v[64:67]
    buffer_load_dwordx4 v149, s[16:19], s45 offen offset:1024 lds
    v_mfma_f32_16x16x32_bf16 v[68:71], a[228:231], a[8:11], v[68:71]
    ds_read_b64_tr_b16 a[246:247], v155 offset:20992
    v_mfma_f32_16x16x32_bf16 v[72:75], a[232:235], a[8:11], v[72:75]
    ds_read_b128 a[40:43], v153 offset:35072
    v_mfma_f32_16x16x32_bf16 v[76:79], a[236:239], a[8:11], v[76:79]
    ds_read_b64_tr_b16 a[248:249], v156 offset:20480
    v_mfma_f32_16x16x32_bf16 v[80:83], a[224:227], a[12:15], v[80:83]
    v_cndmask_b32 v253, 0, v165, vcc
    v_cndmask_b32 v254, 0, v165, vcc
    v_cndmask_b32 v255, 0, v165, vcc
    s_lshl_b32 s61, s36, 10
    s_add_u32 s61, s61, 156160
    v_add_u32 v23, s61, v27
    v_mov_b32 v200, 0
    v_mov_b32 v201, 0
    v_mov_b32 v202, 0
    v_mov_b32 v203, 0
    v_mov_b32 v204, 0
    v_mov_b32 v205, 0
    v_mov_b32 v206, 0
    v_mov_b32 v207, 0
    v_mov_b32 v208, 0
    v_mov_b32 v209, 0
    v_mov_b32 v210, 0
    v_mfma_f32_16x16x32_bf16 v[84:87], a[228:231], a[12:15], v[84:87]
    buffer_load_dwordx4 v150, s[16:19], s45 offen offset:2048 lds
    v_mfma_f32_16x16x32_bf16 v[88:91], a[232:235], a[12:15], v[88:91]
    ds_read_b128 a[44:47], v153 offset:37120
    v_mfma_f32_16x16x32_bf16 v[92:95], a[236:239], a[12:15], v[92:95]
    ds_read_b64_tr_b16 a[250:251], v156 offset:20992
    v_mfma_f32_16x16x32_bf16 v[96:99], a[224:227], a[16:19], v[96:99]
    buffer_load_dwordx4 v151, s[16:19], s45 offen offset:3072 lds
    v_mfma_f32_16x16x32_bf16 v[100:103], a[228:231], a[16:19], v[100:103]
    s_add_u32 m0, s38, 0
    ds_read_b128 a[48:51], v153 offset:39168
    s_add_u32 s45, s39, s57
    v_mfma_f32_16x16x32_bf16 v[104:107], a[232:235], a[16:19], v[104:107]
    ds_read_b64_tr_b16 a[252:253], v157 offset:20480
    v_mfma_f32_16x16x32_bf16 v[108:111], a[236:239], a[16:19], v[108:111]
    ds_read_b128 a[52:55], v153 offset:41216
    v_mfma_f32_16x16x32_bf16 v[112:115], a[224:227], a[20:23], v[112:115]
    ds_read_b64_tr_b16 a[254:255], v157 offset:20992
    v_mfma_f32_16x16x32_bf16 v[116:119], a[228:231], a[20:23], v[116:119]
    buffer_load_dwordx4 v144, s[4:7], s45 offen offset:0 lds
    v_mfma_f32_16x16x32_bf16 v[120:123], a[232:235], a[20:23], v[120:123]
    v_mfma_f32_16x16x32_bf16 v[124:127], a[236:239], a[20:23], v[124:127]
    v_mfma_f32_16x16x32_bf16 v[128:131], a[224:227], a[24:27], v[128:131]
    v_mov_b32 v211, 0
    v_mov_b32 v212, 0
    v_mov_b32 v213, 0
    v_mov_b32 v214, 0
    v_mov_b32 v215, 0
    v_mov_b32 v216, 0
    v_mov_b32 v217, 0
    v_mov_b32 v218, 0
    v_mov_b32 v219, 0
    v_mov_b32 v220, 0
    v_mov_b32 v221, 0
    v_mov_b32 v222, 0
    v_mov_b32 v223, 0
    v_mov_b32 v224, 0
    v_mov_b32 v225, 0
    v_mov_b32 v226, 0
    v_mov_b32 v227, 0
    v_mfma_f32_16x16x32_bf16 v[132:135], a[228:231], a[24:27], v[132:135]
    buffer_load_dwordx4 v145, s[4:7], s45 offen offset:896 lds
    v_mfma_f32_16x16x32_bf16 v[136:139], a[232:235], a[24:27], v[136:139]
    v_mfma_f32_16x16x32_bf16 v[140:143], a[236:239], a[24:27], v[140:143]
    s_waitcnt lgkmcnt(0)
    v_mfma_f32_16x16x32_bf16 v[32:35], a[240:243], a[28:31], v[32:35]
    s_waitcnt vmcnt(6)
    s_barrier
    ds_read_b64_tr_b16 a[224:225], v154 offset:0
    v_mfma_f32_16x16x32_bf16 v[36:39], a[244:247], a[28:31], v[36:39]
    buffer_load_dwordx4 v146, s[4:7], s45 offen offset:1792 lds
    v_mfma_f32_16x16x32_bf16 v[40:43], a[248:251], a[28:31], v[40:43]
    ds_read_b128 a[0:3], v152 offset:43392
    v_mfma_f32_16x16x32_bf16 v[44:47], a[252:255], a[28:31], v[44:47]
    ds_read_b64_tr_b16 a[226:227], v154 offset:512
    v_mfma_f32_16x16x32_bf16 v[48:51], a[240:243], a[32:35], v[48:51]
    buffer_load_dwordx4 v147, s[4:7], s45 offen offset:2688 lds
    v_mfma_f32_16x16x32_bf16 v[52:55], a[244:247], a[32:35], v[52:55]
    s_add_u32 m0, s37, 8192
    s_lshl_b32 s45, s57, 12
    s_add_u32 s45, s45, s40
    v_mfma_f32_16x16x32_bf16 v[56:59], a[248:251], a[32:35], v[56:59]
    ds_read_b128 a[4:7], v152 offset:45440
    v_mfma_f32_16x16x32_bf16 v[60:63], a[252:255], a[32:35], v[60:63]
    ds_read_b64_tr_b16 a[228:229], v155 offset:0
    v_mfma_f32_16x16x32_bf16 v[64:67], a[240:243], a[36:39], v[64:67]
    s_lshl2_add_u32 s65, s49, s36
    s_lshl_b32 s52, s65, 2
    s_lshl_b32 s65, s65, 11
    s_add_u32 s65, s65, 33554432
    s_lshl_b32 s61, s50, 2
    v_lshlrev_b32 v2, 7, v0
    v_cmp_gt_u32 vcc, 14, v0
    v_add_u32 v2, s61, v2
    v_mov_b32 v3, 0x40000000
    v_cndmask_b32 v3, v3, v2, vcc
    v_lshrrev_b32 v2, 2, v0
    v_and_b32 v1, 3, v0
    v_lshlrev_b32 v2, 7, v2
    v_lshl_add_u32 v1, v1, 4, v2
    s_or_b32 s61, s50, s47
    s_cselect_b32 s60, 0x40000000, 0
    v_add_u32 v1, s60, v1
    s_add_u32 s99, s60, s52
    v_mfma_f32_16x16x32_bf16 v[68:71], a[244:247], a[36:39], v[68:71]
    buffer_load_dwordx4 v148, s[16:19], s45 offen offset:0 lds
    v_mfma_f32_16x16x32_bf16 v[72:75], a[248:251], a[36:39], v[72:75]
    ds_read_b128 a[8:11], v152 offset:47488
    v_mfma_f32_16x16x32_bf16 v[76:79], a[252:255], a[36:39], v[76:79]
    ds_read_b64_tr_b16 a[230:231], v155 offset:512
    v_mfma_f32_16x16x32_bf16 v[80:83], a[240:243], a[40:43], v[80:83]
    buffer_load_dwordx4 v149, s[16:19], s45 offen offset:1024 lds
    v_mfma_f32_16x16x32_bf16 v[84:87], a[244:247], a[40:43], v[84:87]
    ds_read_b128 a[12:15], v152 offset:49536
    v_mfma_f32_16x16x32_bf16 v[88:91], a[248:251], a[40:43], v[88:91]
    ds_read_b64_tr_b16 a[232:233], v156 offset:0
    v_mfma_f32_16x16x32_bf16 v[92:95], a[252:255], a[40:43], v[92:95]
    ds_read_b128 a[16:19], v152 offset:51584
    v_mfma_f32_16x16x32_bf16 v[96:99], a[240:243], a[44:47], v[96:99]
    buffer_load_dwordx4 v150, s[16:19], s45 offen offset:2048 lds
    v_mfma_f32_16x16x32_bf16 v[100:103], a[244:247], a[44:47], v[100:103]
    ds_read_b64_tr_b16 a[234:235], v156 offset:512
    v_mfma_f32_16x16x32_bf16 v[104:107], a[248:251], a[44:47], v[104:107]
    ds_read_b128 a[20:23], v152 offset:53632
    v_mfma_f32_16x16x32_bf16 v[108:111], a[252:255], a[44:47], v[108:111]
    ds_read_b64_tr_b16 a[236:237], v157 offset:0
    v_mfma_f32_16x16x32_bf16 v[112:115], a[240:243], a[48:51], v[112:115]
    ds_read_b128 a[24:27], v152 offset:55680
    v_mfma_f32_16x16x32_bf16 v[116:119], a[244:247], a[48:51], v[116:119]
    ds_read_b64_tr_b16 a[238:239], v157 offset:512
    v_mfma_f32_16x16x32_bf16 v[120:123], a[248:251], a[48:51], v[120:123]
    buffer_load_dwordx4 v151, s[16:19], s45 offen offset:3072 lds
    v_mfma_f32_16x16x32_bf16 v[124:127], a[252:255], a[48:51], v[124:127]
    s_add_u32 m0, s37, 12288
    s_add_u32 s45, s45, 262144
    v_mfma_f32_16x16x32_bf16 v[128:131], a[240:243], a[52:55], v[128:131]
    buffer_load_dwordx4 v148, s[16:19], s45 offen offset:0 lds
    v_mfma_f32_16x16x32_bf16 v[132:135], a[244:247], a[52:55], v[132:135]
    v_mfma_f32_16x16x32_bf16 v[136:139], a[248:251], a[52:55], v[136:139]
    v_mfma_f32_16x16x32_bf16 v[140:143], a[252:255], a[52:55], v[140:143]
    s_waitcnt lgkmcnt(0)
    v_mfma_f32_16x16x32_bf16 v[32:35], a[224:227], a[0:3], v[32:35]
    s_waitcnt vmcnt(9)
    ds_read_b64_tr_b16 a[240:241], v154 offset:4096
    v_mfma_f32_16x16x32_bf16 v[36:39], a[228:231], a[0:3], v[36:39]
    buffer_load_dwordx4 v149, s[16:19], s45 offen offset:1024 lds
    v_mfma_f32_16x16x32_bf16 v[40:43], a[232:235], a[0:3], v[40:43]
    ds_read_b128 a[28:31], v153 offset:43392
    v_mfma_f32_16x16x32_bf16 v[44:47], a[236:239], a[0:3], v[44:47]
    ds_read_b64_tr_b16 a[242:243], v154 offset:4608
    v_mfma_f32_16x16x32_bf16 v[48:51], a[224:227], a[4:7], v[48:51]
    buffer_load_dwordx4 v150, s[16:19], s45 offen offset:2048 lds
    v_mfma_f32_16x16x32_bf16 v[52:55], a[228:231], a[4:7], v[52:55]
    ds_read_b128 a[32:35], v153 offset:45440
    v_mfma_f32_16x16x32_bf16 v[56:59], a[232:235], a[4:7], v[56:59]
    ds_read_b64_tr_b16 a[244:245], v155 offset:4096
    v_mfma_f32_16x16x32_bf16 v[60:63], a[236:239], a[4:7], v[60:63]
    ds_read_b128 a[36:39], v153 offset:47488
    v_mfma_f32_16x16x32_bf16 v[64:67], a[224:227], a[8:11], v[64:67]
    buffer_load_dwordx4 v151, s[16:19], s45 offen offset:3072 lds
    v_mfma_f32_16x16x32_bf16 v[68:71], a[228:231], a[8:11], v[68:71]
    s_add_u32 m0, s38, 14464
    s_add_u32 s45, s39, s58
    ds_read_b64_tr_b16 a[246:247], v155 offset:4608
    v_mfma_f32_16x16x32_bf16 v[72:75], a[232:235], a[8:11], v[72:75]
    ds_read_b128 a[40:43], v153 offset:49536
    v_mfma_f32_16x16x32_bf16 v[76:79], a[236:239], a[8:11], v[76:79]
    ds_read_b64_tr_b16 a[248:249], v156 offset:4096
    v_mfma_f32_16x16x32_bf16 v[80:83], a[224:227], a[12:15], v[80:83]
    buffer_load_dwordx4 v144, s[4:7], s45 offen offset:0 lds
    v_mfma_f32_16x16x32_bf16 v[84:87], a[228:231], a[12:15], v[84:87]
    ds_read_b128 a[44:47], v153 offset:51584
    v_mfma_f32_16x16x32_bf16 v[88:91], a[232:235], a[12:15], v[88:91]
    ds_read_b64_tr_b16 a[250:251], v156 offset:4608
    v_mfma_f32_16x16x32_bf16 v[92:95], a[236:239], a[12:15], v[92:95]
    ds_read_b128 a[48:51], v153 offset:53632
    v_mfma_f32_16x16x32_bf16 v[96:99], a[224:227], a[16:19], v[96:99]
    buffer_load_dwordx4 v145, s[4:7], s45 offen offset:896 lds
    v_mfma_f32_16x16x32_bf16 v[100:103], a[228:231], a[16:19], v[100:103]
    ds_read_b64_tr_b16 a[252:253], v157 offset:4096
    v_mfma_f32_16x16x32_bf16 v[104:107], a[232:235], a[16:19], v[104:107]
    ds_read_b128 a[52:55], v153 offset:55680
    v_mfma_f32_16x16x32_bf16 v[108:111], a[236:239], a[16:19], v[108:111]
    ds_read_b64_tr_b16 a[254:255], v157 offset:4608
    v_mfma_f32_16x16x32_bf16 v[112:115], a[224:227], a[20:23], v[112:115]
    buffer_load_dwordx4 v146, s[4:7], s45 offen offset:1792 lds
    v_mfma_f32_16x16x32_bf16 v[116:119], a[228:231], a[20:23], v[116:119]
    v_mfma_f32_16x16x32_bf16 v[120:123], a[232:235], a[20:23], v[120:123]
    v_mfma_f32_16x16x32_bf16 v[124:127], a[236:239], a[20:23], v[124:127]
    v_mfma_f32_16x16x32_bf16 v[128:131], a[224:227], a[24:27], v[128:131]
    buffer_load_dwordx4 v147, s[4:7], s45 offen offset:2688 lds
    v_mfma_f32_16x16x32_bf16 v[132:135], a[228:231], a[24:27], v[132:135]
    s_add_u32 m0, s37, 16384
    s_lshl_b32 s45, s58, 12
    s_add_u32 s45, s45, s40
    v_mfma_f32_16x16x32_bf16 v[136:139], a[232:235], a[24:27], v[136:139]
    v_mfma_f32_16x16x32_bf16 v[140:143], a[236:239], a[24:27], v[140:143]
    s_waitcnt lgkmcnt(0)
    v_mfma_f32_16x16x32_bf16 v[32:35], a[240:243], a[28:31], v[32:35]
    s_waitcnt vmcnt(8)
    s_barrier
    ds_read_b64_tr_b16 a[224:225], v154 offset:8192
    v_mfma_f32_16x16x32_bf16 v[36:39], a[244:247], a[28:31], v[36:39]
    buffer_load_dwordx4 v148, s[16:19], s45 offen offset:0 lds
    v_mfma_f32_16x16x32_bf16 v[40:43], a[248:251], a[28:31], v[40:43]
    ds_read_b128 a[0:3], v152 offset:0
    v_mfma_f32_16x16x32_bf16 v[44:47], a[252:255], a[28:31], v[44:47]
    ds_read_b64_tr_b16 a[226:227], v154 offset:8704
    v_mfma_f32_16x16x32_bf16 v[48:51], a[240:243], a[32:35], v[48:51]
    buffer_load_dwordx4 v149, s[16:19], s45 offen offset:1024 lds
    v_mfma_f32_16x16x32_bf16 v[52:55], a[244:247], a[32:35], v[52:55]
    ds_read_b128 a[4:7], v152 offset:2048
    v_mfma_f32_16x16x32_bf16 v[56:59], a[248:251], a[32:35], v[56:59]
    ds_read_b64_tr_b16 a[228:229], v155 offset:8192
    v_mfma_f32_16x16x32_bf16 v[60:63], a[252:255], a[32:35], v[60:63]
    ds_read_b128 a[8:11], v152 offset:4096
    v_mfma_f32_16x16x32_bf16 v[64:67], a[240:243], a[36:39], v[64:67]
    buffer_load_dwordx4 v150, s[16:19], s45 offen offset:2048 lds
    v_mfma_f32_16x16x32_bf16 v[68:71], a[244:247], a[36:39], v[68:71]
    ds_read_b64_tr_b16 a[230:231], v155 offset:8704
    v_mfma_f32_16x16x32_bf16 v[72:75], a[248:251], a[36:39], v[72:75]
    ds_read_b128 a[12:15], v152 offset:6144
    v_mfma_f32_16x16x32_bf16 v[76:79], a[252:255], a[36:39], v[76:79]
    ds_read_b64_tr_b16 a[232:233], v156 offset:8192
    v_mfma_f32_16x16x32_bf16 v[80:83], a[240:243], a[40:43], v[80:83]
    buffer_load_dwordx4 v151, s[16:19], s45 offen offset:3072 lds
    v_mfma_f32_16x16x32_bf16 v[84:87], a[244:247], a[40:43], v[84:87]
    s_add_u32 m0, s37, 20480
    s_add_u32 s45, s45, 262144
    ds_read_b128 a[16:19], v152 offset:8192
    v_mfma_f32_16x16x32_bf16 v[88:91], a[248:251], a[40:43], v[88:91]
    ds_read_b64_tr_b16 a[234:235], v156 offset:8704
    v_mfma_f32_16x16x32_bf16 v[92:95], a[252:255], a[40:43], v[92:95]
    ds_read_b128 a[20:23], v152 offset:10240
    v_mfma_f32_16x16x32_bf16 v[96:99], a[240:243], a[44:47], v[96:99]
    buffer_load_dwordx4 v148, s[16:19], s45 offen offset:0 lds
    v_mfma_f32_16x16x32_bf16 v[100:103], a[244:247], a[44:47], v[100:103]
    ds_read_b64_tr_b16 a[236:237], v157 offset:8192
    v_mfma_f32_16x16x32_bf16 v[104:107], a[248:251], a[44:47], v[104:107]
    ds_read_b128 a[24:27], v152 offset:12288
    v_mfma_f32_16x16x32_bf16 v[108:111], a[252:255], a[44:47], v[108:111]
    ds_read_b64_tr_b16 a[238:239], v157 offset:8704
    v_mfma_f32_16x16x32_bf16 v[112:115], a[240:243], a[48:51], v[112:115]
    buffer_load_dwordx4 v149, s[16:19], s45 offen offset:1024 lds
    v_mfma_f32_16x16x32_bf16 v[116:119], a[244:247], a[48:51], v[116:119]
    v_mfma_f32_16x16x32_bf16 v[120:123], a[248:251], a[48:51], v[120:123]
    v_mfma_f32_16x16x32_bf16 v[124:127], a[252:255], a[48:51], v[124:127]
    v_mfma_f32_16x16x32_bf16 v[128:131], a[240:243], a[52:55], v[128:131]
    buffer_load_dwordx4 v150, s[16:19], s45 offen offset:2048 lds
    v_mfma_f32_16x16x32_bf16 v[132:135], a[244:247], a[52:55], v[132:135]
    v_mfma_f32_16x16x32_bf16 v[136:139], a[248:251], a[52:55], v[136:139]
    v_mfma_f32_16x16x32_bf16 v[140:143], a[252:255], a[52:55], v[140:143]
    s_waitcnt lgkmcnt(0)
    v_mfma_f32_16x16x32_bf16 v[32:35], a[224:227], a[0:3], v[32:35]
    s_waitcnt vmcnt(11)
    ds_read_b64_tr_b16 a[240:241], v154 offset:12288
    v_mfma_f32_16x16x32_bf16 v[36:39], a[228:231], a[0:3], v[36:39]
    buffer_load_dwordx4 v151, s[16:19], s45 offen offset:3072 lds
    v_mfma_f32_16x16x32_bf16 v[40:43], a[232:235], a[0:3], v[40:43]
    s_add_u32 m0, s38, 28928
    s_add_u32 s45, s39, s59
    ds_read_b128 a[28:31], v153 offset:0
    v_mfma_f32_16x16x32_bf16 v[44:47], a[236:239], a[0:3], v[44:47]
    ds_read_b64_tr_b16 a[242:243], v154 offset:12800
    v_mfma_f32_16x16x32_bf16 v[48:51], a[224:227], a[4:7], v[48:51]
    buffer_load_dwordx4 v144, s[4:7], s45 offen offset:0 lds
    v_mfma_f32_16x16x32_bf16 v[52:55], a[228:231], a[4:7], v[52:55]
    ds_read_b128 a[32:35], v153 offset:2048
    v_mfma_f32_16x16x32_bf16 v[56:59], a[232:235], a[4:7], v[56:59]
    ds_read_b64_tr_b16 a[244:245], v155 offset:12288
    v_mfma_f32_16x16x32_bf16 v[60:63], a[236:239], a[4:7], v[60:63]
    ds_read_b128 a[36:39], v153 offset:4096
    v_mfma_f32_16x16x32_bf16 v[64:67], a[224:227], a[8:11], v[64:67]
    buffer_load_dwordx4 v145, s[4:7], s45 offen offset:896 lds
    v_mfma_f32_16x16x32_bf16 v[68:71], a[228:231], a[8:11], v[68:71]
    ds_read_b64_tr_b16 a[246:247], v155 offset:12800
    v_mfma_f32_16x16x32_bf16 v[72:75], a[232:235], a[8:11], v[72:75]
    ds_read_b128 a[40:43], v153 offset:6144
    v_mfma_f32_16x16x32_bf16 v[76:79], a[236:239], a[8:11], v[76:79]
    ds_read_b64_tr_b16 a[248:249], v156 offset:12288
    v_mfma_f32_16x16x32_bf16 v[80:83], a[224:227], a[12:15], v[80:83]
    buffer_load_dwordx4 v146, s[4:7], s45 offen offset:1792 lds
    v_mfma_f32_16x16x32_bf16 v[84:87], a[228:231], a[12:15], v[84:87]
    ds_read_b128 a[44:47], v153 offset:8192
    v_mfma_f32_16x16x32_bf16 v[88:91], a[232:235], a[12:15], v[88:91]
    ds_read_b64_tr_b16 a[250:251], v156 offset:12800
    v_mfma_f32_16x16x32_bf16 v[92:95], a[236:239], a[12:15], v[92:95]
    ds_read_b128 a[48:51], v153 offset:10240
    v_mfma_f32_16x16x32_bf16 v[96:99], a[224:227], a[16:19], v[96:99]
    buffer_load_dwordx4 v147, s[4:7], s45 offen offset:2688 lds
    v_mfma_f32_16x16x32_bf16 v[100:103], a[228:231], a[16:19], v[100:103]
    s_add_u32 m0, s37, 0
    ds_read_b64_tr_b16 a[252:253], v157 offset:12288
    s_lshl_b32 s45, s59, 12
    v_mfma_f32_16x16x32_bf16 v[104:107], a[232:235], a[16:19], v[104:107]
    s_add_u32 s45, s45, s40
    ds_read_b128 a[52:55], v153 offset:12288
    v_mfma_f32_16x16x32_bf16 v[108:111], a[236:239], a[16:19], v[108:111]
    ds_read_b64_tr_b16 a[254:255], v157 offset:12800
    v_mfma_f32_16x16x32_bf16 v[112:115], a[224:227], a[20:23], v[112:115]
    buffer_load_dwordx4 v148, s[16:19], s45 offen offset:0 lds
    v_mfma_f32_16x16x32_bf16 v[116:119], a[228:231], a[20:23], v[116:119]
    v_mfma_f32_16x16x32_bf16 v[120:123], a[232:235], a[20:23], v[120:123]
    v_mfma_f32_16x16x32_bf16 v[124:127], a[236:239], a[20:23], v[124:127]
    v_mfma_f32_16x16x32_bf16 v[128:131], a[224:227], a[24:27], v[128:131]
    buffer_load_dwordx4 v149, s[16:19], s45 offen offset:1024 lds
    v_mfma_f32_16x16x32_bf16 v[132:135], a[228:231], a[24:27], v[132:135]
    v_mfma_f32_16x16x32_bf16 v[136:139], a[232:235], a[24:27], v[136:139]
    v_mfma_f32_16x16x32_bf16 v[140:143], a[236:239], a[24:27], v[140:143]
    s_waitcnt lgkmcnt(0)
    v_mfma_f32_16x16x32_bf16 v[32:35], a[240:243], a[28:31], v[32:35]
    s_waitcnt vmcnt(10)
    s_barrier
    ds_read_b64_tr_b16 a[224:225], v154 offset:16384
    v_mfma_f32_16x16x32_bf16 v[36:39], a[244:247], a[28:31], v[36:39]
    buffer_load_dwordx4 v150, s[16:19], s45 offen offset:2048 lds
    v_mfma_f32_16x16x32_bf16 v[40:43], a[248:251], a[28:31], v[40:43]
    ds_read_b128 a[0:3], v152 offset:14464
    v_mfma_f32_16x16x32_bf16 v[44:47], a[252:255], a[28:31], v[44:47]
    ds_read_b64_tr_b16 a[226:227], v154 offset:16896
    v_mfma_f32_16x16x32_bf16 v[48:51], a[240:243], a[32:35], v[48:51]
    buffer_load_dwordx4 v151, s[16:19], s45 offen offset:3072 lds
    v_mfma_f32_16x16x32_bf16 v[52:55], a[244:247], a[32:35], v[52:55]
    s_add_u32 m0, s37, 4096
    s_add_u32 s45, s45, 262144
    ds_read_b128 a[4:7], v152 offset:16512
    v_mfma_f32_16x16x32_bf16 v[56:59], a[248:251], a[32:35], v[56:59]
    ds_read_b64_tr_b16 a[228:229], v155 offset:16384
    v_mfma_f32_16x16x32_bf16 v[60:63], a[252:255], a[32:35], v[60:63]
    ds_read_b128 a[8:11], v152 offset:18560
    v_mfma_f32_16x16x32_bf16 v[64:67], a[240:243], a[36:39], v[64:67]
    buffer_load_dwordx4 v148, s[16:19], s45 offen offset:0 lds
    v_mfma_f32_16x16x32_bf16 v[68:71], a[244:247], a[36:39], v[68:71]
    ds_read_b64_tr_b16 a[230:231], v155 offset:16896
    v_mfma_f32_16x16x32_bf16 v[72:75], a[248:251], a[36:39], v[72:75]
    ds_read_b128 a[12:15], v152 offset:20608
    v_mfma_f32_16x16x32_bf16 v[76:79], a[252:255], a[36:39], v[76:79]
    ds_read_b64_tr_b16 a[232:233], v156 offset:16384
    v_mfma_f32_16x16x32_bf16 v[80:83], a[240:243], a[40:43], v[80:83]
    buffer_load_dwordx4 v149, s[16:19], s45 offen offset:1024 lds
    v_mfma_f32_16x16x32_bf16 v[84:87], a[244:247], a[40:43], v[84:87]
    ds_read_b128 a[16:19], v152 offset:22656
    v_mfma_f32_16x16x32_bf16 v[88:91], a[248:251], a[40:43], v[88:91]
    ds_read_b64_tr_b16 a[234:235], v156 offset:16896
    v_mfma_f32_16x16x32_bf16 v[92:95], a[252:255], a[40:43], v[92:95]
    ds_read_b128 a[20:23], v152 offset:24704
    v_mfma_f32_16x16x32_bf16 v[96:99], a[240:243], a[44:47], v[96:99]
    buffer_load_dwordx4 v150, s[16:19], s45 offen offset:2048 lds
    v_mfma_f32_16x16x32_bf16 v[100:103], a[244:247], a[44:47], v[100:103]
    ds_read_b64_tr_b16 a[236:237], v157 offset:16384
    v_mfma_f32_16x16x32_bf16 v[104:107], a[248:251], a[44:47], v[104:107]
    ds_read_b128 a[24:27], v152 offset:26752
    v_mfma_f32_16x16x32_bf16 v[108:111], a[252:255], a[44:47], v[108:111]
    ds_read_b64_tr_b16 a[238:239], v157 offset:16896
    v_mfma_f32_16x16x32_bf16 v[112:115], a[240:243], a[48:51], v[112:115]
    buffer_load_dwordx4 v151, s[16:19], s45 offen offset:3072 lds
    v_mfma_f32_16x16x32_bf16 v[116:119], a[244:247], a[48:51], v[116:119]
    s_add_u32 m0, s37, 8192
    s_add_u32 s45, s41, 0
    v_mfma_f32_16x16x32_bf16 v[120:123], a[248:251], a[48:51], v[120:123]
    v_mfma_f32_16x16x32_bf16 v[124:127], a[252:255], a[48:51], v[124:127]
    v_mfma_f32_16x16x32_bf16 v[128:131], a[240:243], a[52:55], v[128:131]
    buffer_load_dwordx4 v4, s[8:11], s45 offen offset:0 nt lds
    v_mfma_f32_16x16x32_bf16 v[132:135], a[244:247], a[52:55], v[132:135]
    v_mfma_f32_16x16x32_bf16 v[136:139], a[248:251], a[52:55], v[136:139]
    v_mfma_f32_16x16x32_bf16 v[140:143], a[252:255], a[52:55], v[140:143]
    s_waitcnt lgkmcnt(0)
    v_mfma_f32_16x16x32_bf16 v[32:35], a[224:227], a[0:3], v[32:35]
    s_waitcnt vmcnt(13)
    ds_read_b64_tr_b16 a[240:241], v154 offset:20480
    v_mfma_f32_16x16x32_bf16 v[36:39], a[228:231], a[0:3], v[36:39]
    ds_read_b128 a[28:31], v153 offset:14464
    v_mfma_f32_16x16x32_bf16 v[40:43], a[232:235], a[0:3], v[40:43]
    ds_read_b64_tr_b16 a[242:243], v154 offset:20992
    v_mfma_f32_16x16x32_bf16 v[44:47], a[236:239], a[0:3], v[44:47]
    buffer_load_dwordx4 v5, s[8:11], s45 offen offset:1024 nt lds
    v_mfma_f32_16x16x32_bf16 v[48:51], a[224:227], a[4:7], v[48:51]
    ds_read_b128 a[32:35], v153 offset:16512
    v_mfma_f32_16x16x32_bf16 v[52:55], a[228:231], a[4:7], v[52:55]
    ds_read_b64_tr_b16 a[244:245], v155 offset:20480
    v_mfma_f32_16x16x32_bf16 v[56:59], a[232:235], a[4:7], v[56:59]
    ds_read_b128 a[36:39], v153 offset:18560
    v_mfma_f32_16x16x32_bf16 v[60:63], a[236:239], a[4:7], v[60:63]
    ds_read_b64_tr_b16 a[246:247], v155 offset:20992
    v_mfma_f32_16x16x32_bf16 v[64:67], a[224:227], a[8:11], v[64:67]
    ds_read_b128 a[40:43], v153 offset:20608
    v_mfma_f32_16x16x32_bf16 v[68:71], a[228:231], a[8:11], v[68:71]
    ds_read_b64_tr_b16 a[248:249], v156 offset:20480
    v_mfma_f32_16x16x32_bf16 v[72:75], a[232:235], a[8:11], v[72:75]
    buffer_load_dwordx4 v6, s[8:11], s45 offen offset:2048 nt lds
    v_mfma_f32_16x16x32_bf16 v[76:79], a[236:239], a[8:11], v[76:79]
    ds_read_b128 a[44:47], v153 offset:22656
    v_mfma_f32_16x16x32_bf16 v[80:83], a[224:227], a[12:15], v[80:83]
    ds_read_b64_tr_b16 a[250:251], v156 offset:20992
    v_mfma_f32_16x16x32_bf16 v[84:87], a[228:231], a[12:15], v[84:87]
    ds_read_b128 a[48:51], v153 offset:24704
    v_mfma_f32_16x16x32_bf16 v[88:91], a[232:235], a[12:15], v[88:91]
    ds_read_b64_tr_b16 a[252:253], v157 offset:20480
    v_mfma_f32_16x16x32_bf16 v[92:95], a[236:239], a[12:15], v[92:95]
    ds_read_b128 a[52:55], v153 offset:26752
    v_mfma_f32_16x16x32_bf16 v[96:99], a[224:227], a[16:19], v[96:99]
    ds_read_b64_tr_b16 a[254:255], v157 offset:20992
    v_mfma_f32_16x16x32_bf16 v[100:103], a[228:231], a[16:19], v[100:103]
    buffer_load_dwordx4 v7, s[8:11], s45 offen offset:3072 nt lds
    v_mfma_f32_16x16x32_bf16 v[104:107], a[232:235], a[16:19], v[104:107]
    v_mfma_f32_16x16x32_bf16 v[108:111], a[236:239], a[16:19], v[108:111]
    v_mfma_f32_16x16x32_bf16 v[112:115], a[224:227], a[20:23], v[112:115]
    s_add_u32 m0, s37, 12288
    s_add_u32 s45, s41, 256
    v_mfma_f32_16x16x32_bf16 v[116:119], a[228:231], a[20:23], v[116:119]
    v_mfma_f32_16x16x32_bf16 v[120:123], a[232:235], a[20:23], v[120:123]
    v_mfma_f32_16x16x32_bf16 v[124:127], a[236:239], a[20:23], v[124:127]
    v_mfma_f32_16x16x32_bf16 v[128:131], a[224:227], a[24:27], v[128:131]
    buffer_load_dwordx4 v4, s[8:11], s45 offen offset:0 nt lds
    v_mfma_f32_16x16x32_bf16 v[132:135], a[228:231], a[24:27], v[132:135]
    v_mfma_f32_16x16x32_bf16 v[136:139], a[232:235], a[24:27], v[136:139]
    v_mfma_f32_16x16x32_bf16 v[140:143], a[236:239], a[24:27], v[140:143]
    s_waitcnt lgkmcnt(0)
    v_mfma_f32_16x16x32_bf16 v[32:35], a[240:243], a[28:31], v[32:35]
    s_waitcnt vmcnt(9)
    s_barrier
    ds_read_b64_tr_b16 a[224:225], v154 offset:0
    v_mfma_f32_16x16x32_bf16 v[36:39], a[244:247], a[28:31], v[36:39]
    ds_read_b128 a[0:3], v152 offset:28928
    v_mfma_f32_16x16x32_bf16 v[40:43], a[248:251], a[28:31], v[40:43]
    ds_read_b64_tr_b16 a[226:227], v154 offset:512
    v_mfma_f32_16x16x32_bf16 v[44:47], a[252:255], a[28:31], v[44:47]
    buffer_load_dwordx4 v5, s[8:11], s45 offen offset:1024 nt lds
    v_mfma_f32_16x16x32_bf16 v[48:51], a[240:243], a[32:35], v[48:51]
    ds_read_b128 a[4:7], v152 offset:30976
    v_mfma_f32_16x16x32_bf16 v[52:55], a[244:247], a[32:35], v[52:55]
    ds_read_b64_tr_b16 a[228:229], v155 offset:0
    v_mfma_f32_16x16x32_bf16 v[56:59], a[248:251], a[32:35], v[56:59]
    ds_read_b128 a[8:11], v152 offset:33024
    v_mfma_f32_16x16x32_bf16 v[60:63], a[252:255], a[32:35], v[60:63]
    ds_read_b64_tr_b16 a[230:231], v155 offset:512
    v_mfma_f32_16x16x32_bf16 v[64:67], a[240:243], a[36:39], v[64:67]
    ds_read_b128 a[12:15], v152 offset:35072
    v_mfma_f32_16x16x32_bf16 v[68:71], a[244:247], a[36:39], v[68:71]
    ds_read_b64_tr_b16 a[232:233], v156 offset:0
    v_mfma_f32_16x16x32_bf16 v[72:75], a[248:251], a[36:39], v[72:75]
    ds_read_b128 a[16:19], v152 offset:37120
    v_mfma_f32_16x16x32_bf16 v[76:79], a[252:255], a[36:39], v[76:79]
    buffer_load_dwordx4 v6, s[8:11], s45 offen offset:2048 nt lds
    v_mfma_f32_16x16x32_bf16 v[80:83], a[240:243], a[40:43], v[80:83]
    ds_read_b64_tr_b16 a[234:235], v156 offset:512
    v_mfma_f32_16x16x32_bf16 v[84:87], a[244:247], a[40:43], v[84:87]
    ds_read_b128 a[20:23], v152 offset:39168
    v_mfma_f32_16x16x32_bf16 v[88:91], a[248:251], a[40:43], v[88:91]
    ds_read_b64_tr_b16 a[236:237], v157 offset:0
    v_mfma_f32_16x16x32_bf16 v[92:95], a[252:255], a[40:43], v[92:95]
    ds_read_b128 a[24:27], v152 offset:41216
    v_mfma_f32_16x16x32_bf16 v[96:99], a[240:243], a[44:47], v[96:99]
    ds_read_b64_tr_b16 a[238:239], v157 offset:512
    v_mfma_f32_16x16x32_bf16 v[100:103], a[244:247], a[44:47], v[100:103]
    v_mfma_f32_16x16x32_bf16 v[104:107], a[248:251], a[44:47], v[104:107]
    buffer_load_dwordx4 v7, s[8:11], s45 offen offset:3072 nt lds
    v_mfma_f32_16x16x32_bf16 v[108:111], a[252:255], a[44:47], v[108:111]
    v_mfma_f32_16x16x32_bf16 v[112:115], a[240:243], a[48:51], v[112:115]
    v_mfma_f32_16x16x32_bf16 v[116:119], a[244:247], a[48:51], v[116:119]
    s_add_u32 m0, s37, 16384
    s_add_u32 s45, s41, 8192
    v_mfma_f32_16x16x32_bf16 v[120:123], a[248:251], a[48:51], v[120:123]
    v_mfma_f32_16x16x32_bf16 v[124:127], a[252:255], a[48:51], v[124:127]
    v_mfma_f32_16x16x32_bf16 v[128:131], a[240:243], a[52:55], v[128:131]
    v_mfma_f32_16x16x32_bf16 v[132:135], a[244:247], a[52:55], v[132:135]
    buffer_load_dwordx4 v4, s[8:11], s45 offen offset:0 nt lds
    v_mfma_f32_16x16x32_bf16 v[136:139], a[248:251], a[52:55], v[136:139]
    v_mfma_f32_16x16x32_bf16 v[140:143], a[252:255], a[52:55], v[140:143]
    s_waitcnt lgkmcnt(0)
    v_mfma_f32_16x16x32_bf16 v[32:35], a[224:227], a[0:3], v[32:35]
    s_waitcnt vmcnt(9)
    ds_read_b64_tr_b16 a[240:241], v154 offset:4096
    v_mfma_f32_16x16x32_bf16 v[36:39], a[228:231], a[0:3], v[36:39]
    ds_read_b64_tr_b16 a[242:243], v154 offset:4608
    v_mfma_f32_16x16x32_bf16 v[40:43], a[232:235], a[0:3], v[40:43]
    ds_read_b128 a[28:31], v153 offset:28928
    v_mfma_f32_16x16x32_bf16 v[44:47], a[236:239], a[0:3], v[44:47]
    ds_read_b64_tr_b16 a[244:245], v155 offset:4096
    v_mfma_f32_16x16x32_bf16 v[48:51], a[224:227], a[4:7], v[48:51]
    ds_read_b64_tr_b16 a[246:247], v155 offset:4608
    v_mfma_f32_16x16x32_bf16 v[52:55], a[228:231], a[4:7], v[52:55]
    buffer_load_dwordx4 v5, s[8:11], s45 offen offset:1024 nt lds
    v_mfma_f32_16x16x32_bf16 v[56:59], a[232:235], a[4:7], v[56:59]
    ds_read_b64_tr_b16 a[248:249], v156 offset:4096
    v_mfma_f32_16x16x32_bf16 v[60:63], a[236:239], a[4:7], v[60:63]
    ds_read_b64_tr_b16 a[250:251], v156 offset:4608
    v_mfma_f32_16x16x32_bf16 v[64:67], a[224:227], a[8:11], v[64:67]
    ds_read_b64_tr_b16 a[252:253], v157 offset:4096
    v_mfma_f32_16x16x32_bf16 v[68:71], a[228:231], a[8:11], v[68:71]
    ds_read_b64_tr_b16 a[254:255], v157 offset:4608
    v_mfma_f32_16x16x32_bf16 v[72:75], a[232:235], a[8:11], v[72:75]
    ds_read_b128 a[32:35], v153 offset:30976
    v_mfma_f32_16x16x32_bf16 v[76:79], a[236:239], a[8:11], v[76:79]
    ds_read_b128 a[36:39], v153 offset:33024
    s_waitcnt lgkmcnt(7)
    v_mfma_f32_16x16x32_bf16 v[32:35], a[240:243], a[28:31], v[32:35]
    ds_read_b128 a[40:43], v153 offset:35072
    s_waitcnt lgkmcnt(7)
    v_mfma_f32_16x16x32_bf16 v[36:39], a[244:247], a[28:31], v[36:39]
    buffer_load_dwordx4 v6, s[8:11], s45 offen offset:2048 nt lds
    s_waitcnt lgkmcnt(5)
    v_mfma_f32_16x16x32_bf16 v[40:43], a[248:251], a[28:31], v[40:43]
    ds_read_b128 a[44:47], v153 offset:37120
    s_waitcnt lgkmcnt(4)
    v_mfma_f32_16x16x32_bf16 v[44:47], a[252:255], a[28:31], v[44:47]
    ds_read_b128 a[48:51], v153 offset:39168
    v_mfma_f32_16x16x32_bf16 v[80:83], a[224:227], a[12:15], v[80:83]
    ds_read_b128 a[52:55], v153 offset:41216
    v_mfma_f32_16x16x32_bf16 v[84:87], a[228:231], a[12:15], v[84:87]
    v_mfma_f32_16x16x32_bf16 v[88:91], a[232:235], a[12:15], v[88:91]
    v_mul_f32 v32, s48, v32
    v_mul_f32 v33, s48, v33
    v_mfma_f32_16x16x32_bf16 v[92:95], a[236:239], a[12:15], v[92:95]
    buffer_load_dwordx4 v7, s[8:11], s45 offen offset:3072 nt lds
    s_waitcnt lgkmcnt(3)
    v_mfma_f32_16x16x32_bf16 v[48:51], a[240:243], a[32:35], v[48:51]
    v_mul_f32 v34, s48, v34
    v_mul_f32 v35, s48, v35
    v_mfma_f32_16x16x32_bf16 v[52:55], a[244:247], a[32:35], v[52:55]
    v_mul_f32 v36, s48, v36
    v_mul_f32 v37, s48, v37
    v_mfma_f32_16x16x32_bf16 v[56:59], a[248:251], a[32:35], v[56:59]
    s_waitcnt lgkmcnt(0)
    s_barrier
    s_add_u32 m0, s37, 20480
    v_mfma_f32_16x16x32_bf16 v[60:63], a[252:255], a[32:35], v[60:63]
    s_add_u32 s45, s41, 8448
    v_mul_f32 v38, s48, v38
    v_mul_f32 v39, s48, v39
    v_mfma_f32_16x16x32_bf16 v[96:99], a[224:227], a[16:19], v[96:99]
    v_cvt_pk_bf16_f32 v32, v32, v33
    v_cvt_pk_bf16_f32 v33, v34, v35
    v_mfma_f32_16x16x32_bf16 v[100:103], a[228:231], a[16:19], v[100:103]
    v_cvt_pk_bf16_f32 v34, v36, v37
    v_cvt_pk_bf16_f32 v35, v38, v39
    v_mfma_f32_16x16x32_bf16 v[104:107], a[232:235], a[16:19], v[104:107]
    buffer_load_dwordx4 v4, s[8:11], s45 offen offset:0 nt lds
    v_mfma_f32_16x16x32_bf16 v[108:111], a[236:239], a[16:19], v[108:111]
    v_mul_f32 v40, s48, v40
    v_mul_f32 v41, s48, v41
    v_mfma_f32_16x16x32_bf16 v[64:67], a[240:243], a[36:39], v[64:67]
    ds_write_b128 v22, v[32:35] offset:0
    v_mfma_f32_16x16x32_bf16 v[68:71], a[244:247], a[36:39], v[68:71]
    v_mul_f32 v42, s48, v42
    v_mul_f32 v43, s48, v43
    v_mfma_f32_16x16x32_bf16 v[72:75], a[248:251], a[36:39], v[72:75]
    v_mul_f32 v44, s48, v44
    v_mul_f32 v45, s48, v45
    v_mfma_f32_16x16x32_bf16 v[76:79], a[252:255], a[36:39], v[76:79]
    v_mul_f32 v46, s48, v46
    v_mul_f32 v47, s48, v47
    v_mfma_f32_16x16x32_bf16 v[112:115], a[224:227], a[20:23], v[112:115]
    v_cvt_pk_bf16_f32 v40, v40, v41
    v_cvt_pk_bf16_f32 v41, v42, v43
    v_mfma_f32_16x16x32_bf16 v[116:119], a[228:231], a[20:23], v[116:119]
    buffer_load_dwordx4 v5, s[8:11], s45 offen offset:1024 nt lds
    v_mfma_f32_16x16x32_bf16 v[120:123], a[232:235], a[20:23], v[120:123]
    v_cvt_pk_bf16_f32 v42, v44, v45
    v_cvt_pk_bf16_f32 v43, v46, v47
    v_mfma_f32_16x16x32_bf16 v[124:127], a[236:239], a[20:23], v[124:127]
    v_mul_f32 v48, s48, v48
    v_mul_f32 v49, s48, v49
    v_mfma_f32_16x16x32_bf16 v[80:83], a[240:243], a[40:43], v[80:83]
    ds_write_b128 v22, v[40:43] offset:7168
    v_mfma_f32_16x16x32_bf16 v[84:87], a[244:247], a[40:43], v[84:87]
    v_mul_f32 v50, s48, v50
    v_mul_f32 v51, s48, v51
    v_mfma_f32_16x16x32_bf16 v[88:91], a[248:251], a[40:43], v[88:91]
    v_mul_f32 v52, s48, v52
    v_mul_f32 v53, s48, v53
    v_mfma_f32_16x16x32_bf16 v[92:95], a[252:255], a[40:43], v[92:95]
    v_mul_f32 v54, s48, v54
    v_mul_f32 v55, s48, v55
    v_mfma_f32_16x16x32_bf16 v[128:131], a[224:227], a[24:27], v[128:131]
    buffer_load_dwordx4 v6, s[8:11], s45 offen offset:2048 nt lds
    v_mfma_f32_16x16x32_bf16 v[132:135], a[228:231], a[24:27], v[132:135]
    v_cvt_pk_bf16_f32 v48, v48, v49
    v_cvt_pk_bf16_f32 v49, v50, v51
    v_mfma_f32_16x16x32_bf16 v[136:139], a[232:235], a[24:27], v[136:139]
    v_cvt_pk_bf16_f32 v50, v52, v53
    v_cvt_pk_bf16_f32 v51, v54, v55
    v_mfma_f32_16x16x32_bf16 v[140:143], a[236:239], a[24:27], v[140:143]
    s_waitcnt vmcnt(11)
    v_mul_f32 v56, s48, v56
    v_mul_f32 v57, s48, v57
    v_mfma_f32_16x16x32_bf16 v[96:99], a[240:243], a[44:47], v[96:99]
    ds_read_b128 a[224:227], v8 offset:8192
    v_mfma_f32_16x16x32_bf16 v[100:103], a[244:247], a[44:47], v[100:103]
    ds_read_b128 a[228:231], v9 offset:8192
    v_mfma_f32_16x16x32_bf16 v[104:107], a[248:251], a[44:47], v[104:107]
    ds_read_b128 a[232:235], v10 offset:8192
    v_mfma_f32_16x16x32_bf16 v[108:111], a[252:255], a[44:47], v[108:111]
    buffer_load_dwordx4 v7, s[8:11], s45 offen offset:3072 nt lds
    v_mfma_f32_16x16x32_bf16 v[112:115], a[240:243], a[48:51], v[112:115]
    ds_read_b128 a[236:239], v11 offset:8192
    v_mfma_f32_16x16x32_bf16 v[116:119], a[244:247], a[48:51], v[116:119]
    ds_write_b128 v22, v[48:51] offset:1024
    v_mfma_f32_16x16x32_bf16 v[120:123], a[248:251], a[48:51], v[120:123]
    v_mul_f32 v58, s48, v58
    v_mul_f32 v59, s48, v59
    v_mfma_f32_16x16x32_bf16 v[124:127], a[252:255], a[48:51], v[124:127]
    s_add_u32 m0, s37, 0
    s_add_u32 s45, s41, 65536
    v_mul_f32 v60, s48, v60
    v_mfma_f32_16x16x32_bf16 v[128:131], a[240:243], a[52:55], v[128:131]
    v_mul_f32 v61, s48, v61
    v_mul_f32 v62, s48, v62
    v_mfma_f32_16x16x32_bf16 v[132:135], a[244:247], a[52:55], v[132:135]
    v_mul_f32 v63, s48, v63
    v_cvt_pk_bf16_f32 v56, v56, v57
    v_mfma_f32_16x16x32_bf16 v[136:139], a[248:251], a[52:55], v[136:139]
    v_cvt_pk_bf16_f32 v57, v58, v59
    v_cvt_pk_bf16_f32 v58, v60, v61
    v_mfma_f32_16x16x32_bf16 v[140:143], a[252:255], a[52:55], v[140:143]
    buffer_load_dwordx4 v4, s[8:11], s45 offen offset:0 nt lds
    v_cvt_pk_bf16_f32 v59, v62, v63
    v_pk_mul_f32 v[64:65], v[64:65], s[48:49] op_sel_hi:[1,0]
    ds_write_b128 v22, v[56:59] offset:8192
    v_pk_mul_f32 v[66:67], v[66:67], s[48:49] op_sel_hi:[1,0]
    v_pk_mul_f32 v[68:69], v[68:69], s[48:49] op_sel_hi:[1,0]
    v_pk_mul_f32 v[70:71], v[70:71], s[48:49] op_sel_hi:[1,0]
    v_cvt_pk_bf16_f32 v64, v64, v65
    v_cvt_pk_bf16_f32 v65, v66, v67
    v_cvt_pk_bf16_f32 v66, v68, v69
    v_cvt_pk_bf16_f32 v67, v70, v71
    v_pk_mul_f32 v[72:73], v[72:73], s[48:49] op_sel_hi:[1,0]
    ds_write_b128 v22, v[64:67] offset:2048
    buffer_load_dwordx4 v5, s[8:11], s45 offen offset:1024 nt lds
    v_pk_mul_f32 v[74:75], v[74:75], s[48:49] op_sel_hi:[1,0]
    v_pk_mul_f32 v[76:77], v[76:77], s[48:49] op_sel_hi:[1,0]
    v_pk_mul_f32 v[78:79], v[78:79], s[48:49] op_sel_hi:[1,0]
    v_cvt_pk_bf16_f32 v72, v72, v73
    v_cvt_pk_bf16_f32 v73, v74, v75
    v_cvt_pk_bf16_f32 v74, v76, v77
    v_cvt_pk_bf16_f32 v75, v78, v79
    v_pk_mul_f32 v[80:81], v[80:81], s[48:49] op_sel_hi:[1,0]
    ds_write_b128 v22, v[72:75] offset:9216
    v_pk_mul_f32 v[82:83], v[82:83], s[48:49] op_sel_hi:[1,0]
    v_pk_mul_f32 v[84:85], v[84:85], s[48:49] op_sel_hi:[1,0]
    v_pk_mul_f32 v[86:87], v[86:87], s[48:49] op_sel_hi:[1,0]
    v_cvt_pk_bf16_f32 v80, v80, v81
    buffer_load_dwordx4 v6, s[8:11], s45 offen offset:2048 nt lds
    v_cvt_pk_bf16_f32 v81, v82, v83
    v_cvt_pk_bf16_f32 v82, v84, v85
    v_cvt_pk_bf16_f32 v83, v86, v87
    v_pk_mul_f32 v[88:89], v[88:89], s[48:49] op_sel_hi:[1,0]
    ds_write_b128 v22, v[80:83] offset:3072
    v_pk_mul_f32 v[90:91], v[90:91], s[48:49] op_sel_hi:[1,0]
    v_pk_mul_f32 v[92:93], v[92:93], s[48:49] op_sel_hi:[1,0]
    v_pk_mul_f32 v[94:95], v[94:95], s[48:49] op_sel_hi:[1,0]
    v_cvt_pk_bf16_f32 v88, v88, v89
    v_cvt_pk_bf16_f32 v89, v90, v91
    v_cvt_pk_bf16_f32 v90, v92, v93
    v_cvt_pk_bf16_f32 v91, v94, v95
    v_pk_mul_f32 v[96:97], v[96:97], s[48:49] op_sel_hi:[1,0]
    ds_write_b128 v22, v[88:91] offset:10240
    buffer_load_dwordx4 v7, s[8:11], s45 offen offset:3072 nt lds
    v_pk_mul_f32 v[98:99], v[98:99], s[48:49] op_sel_hi:[1,0]
    v_pk_mul_f32 v[100:101], v[100:101], s[48:49] op_sel_hi:[1,0]
    v_pk_mul_f32 v[102:103], v[102:103], s[48:49] op_sel_hi:[1,0]
    v_cvt_pk_bf16_f32 v96, v96, v97
    v_cvt_pk_bf16_f32 v97, v98, v99
    v_cvt_pk_bf16_f32 v98, v100, v101
    s_add_u32 m0, s37, 4096
    s_add_u32 s45, s41, 65792
    v_cvt_pk_bf16_f32 v99, v102, v103
    v_pk_mul_f32 v[104:105], v[104:105], s[48:49] op_sel_hi:[1,0]
    ds_write_b128 v22, v[96:99] offset:4096
    v_pk_mul_f32 v[106:107], v[106:107], s[48:49] op_sel_hi:[1,0]
    v_pk_mul_f32 v[108:109], v[108:109], s[48:49] op_sel_hi:[1,0]
    v_pk_mul_f32 v[110:111], v[110:111], s[48:49] op_sel_hi:[1,0]
    v_cvt_pk_bf16_f32 v104, v104, v105
    buffer_load_dwordx4 v4, s[8:11], s45 offen offset:0 nt lds
    v_cvt_pk_bf16_f32 v105, v106, v107
    v_cvt_pk_bf16_f32 v106, v108, v109
    v_cvt_pk_bf16_f32 v107, v110, v111
    v_pk_mul_f32 v[112:113], v[112:113], s[48:49] op_sel_hi:[1,0]
    ds_write_b128 v22, v[104:107] offset:11264
    v_pk_mul_f32 v[114:115], v[114:115], s[48:49] op_sel_hi:[1,0]
    v_pk_mul_f32 v[116:117], v[116:117], s[48:49] op_sel_hi:[1,0]
    v_pk_mul_f32 v[118:119], v[118:119], s[48:49] op_sel_hi:[1,0]
    v_cvt_pk_bf16_f32 v112, v112, v113
    v_cvt_pk_bf16_f32 v113, v114, v115
    v_cvt_pk_bf16_f32 v114, v116, v117
    v_cvt_pk_bf16_f32 v115, v118, v119
    v_pk_mul_f32 v[120:121], v[120:121], s[48:49] op_sel_hi:[1,0]
    ds_write_b128 v22, v[112:115] offset:5120
    v_pk_mul_f32 v[122:123], v[122:123], s[48:49] op_sel_hi:[1,0]
    v_pk_mul_f32 v[124:125], v[124:125], s[48:49] op_sel_hi:[1,0]
    buffer_load_dwordx4 v5, s[8:11], s45 offen offset:1024 nt lds
    v_pk_mul_f32 v[126:127], v[126:127], s[48:49] op_sel_hi:[1,0]
    v_cvt_pk_bf16_f32 v120, v120, v121
    v_cvt_pk_bf16_f32 v121, v122, v123
    v_cvt_pk_bf16_f32 v122, v124, v125
    v_cvt_pk_bf16_f32 v123, v126, v127
    v_pk_mul_f32 v[128:129], v[128:129], s[48:49] op_sel_hi:[1,0]
    ds_write_b128 v22, v[120:123] offset:12288
    v_pk_mul_f32 v[130:131], v[130:131], s[48:49] op_sel_hi:[1,0]
    v_pk_mul_f32 v[132:133], v[132:133], s[48:49] op_sel_hi:[1,0]
    v_pk_mul_f32 v[134:135], v[134:135], s[48:49] op_sel_hi:[1,0]
    v_cvt_pk_bf16_f32 v128, v128, v129
    v_cvt_pk_bf16_f32 v129, v130, v131
    v_cvt_pk_bf16_f32 v130, v132, v133
    buffer_load_dwordx4 v6, s[8:11], s45 offen offset:2048 nt lds
    v_cvt_pk_bf16_f32 v131, v134, v135
    v_pk_mul_f32 v[136:137], v[136:137], s[48:49] op_sel_hi:[1,0]
    ds_write_b128 v22, v[128:131] offset:6144
    v_pk_mul_f32 v[138:139], v[138:139], s[48:49] op_sel_hi:[1,0]
    v_pk_mul_f32 v[140:141], v[140:141], s[48:49] op_sel_hi:[1,0]
    v_pk_mul_f32 v[142:143], v[142:143], s[48:49] op_sel_hi:[1,0]
    v_cvt_pk_bf16_f32 v136, v136, v137
    v_cvt_pk_bf16_f32 v137, v138, v139
    v_cvt_pk_bf16_f32 v138, v140, v141
    v_cvt_pk_bf16_f32 v139, v142, v143
    ds_write_b128 v22, v[136:139] offset:13312
    buffer_load_dwordx4 v7, s[8:11], s45 offen offset:3072 nt lds
    s_waitcnt lgkmcnt(0)
    s_barrier
    s_cmp_lg_u32 s47, 0
    s_cbranch_scc1 L_slow
L_fast:
    ds_read_b128 a[0:3], v20 offset:0
    ds_read_b128 a[28:31], v20 offset:7168
    ds_read_b128 a[56:59], v20 offset:14336
    ds_read_b128 a[84:87], v20 offset:21504
    ds_read_b128 a[4:7], v20 offset:1024
    ds_read_b128 a[32:35], v20 offset:8192
    ds_read_b128 a[60:63], v20 offset:15360
    ds_read_b128 a[88:91], v20 offset:22528
    ds_read_b128 a[8:11], v20 offset:2048
    ds_read_b128 a[36:39], v20 offset:9216
    s_waitcnt lgkmcnt(9)
    v_mfma_f32_16x16x32_bf16 v[60:63], a[224:227], a[0:3], v[200:203]
    s_add_u32 m0, s37, 8192
    ds_read_b128 a[64:67], v20 offset:16384
    s_add_u32 s45, s41, 73728
    s_waitcnt lgkmcnt(9)
    v_mfma_f32_16x16x32_bf16 v[60:63], a[228:231], a[28:31], v[60:63]
    ds_read_b128 a[92:95], v20 offset:23552
    s_waitcnt lgkmcnt(9)
    v_mfma_f32_16x16x32_bf16 v[60:63], a[232:235], a[56:59], v[60:63]
    ds_read_b128 a[12:15], v20 offset:3072
    s_waitcnt lgkmcnt(7)
    v_mfma_f32_16x16x32_bf16 v[60:63], a[236:239], a[84:87], v[60:63]
    ds_read_b128 a[40:43], v20 offset:10240
    v_mfma_f32_16x16x32_bf16 v[64:67], a[224:227], a[4:7], v[204:207]
    ds_read_b128 a[68:71], v20 offset:17408
    v_mfma_f32_16x16x32_bf16 v[64:67], a[228:231], a[32:35], v[64:67]
    buffer_load_dwordx4 v4, s[8:11], s45 offen offset:0 nt lds
    s_waitcnt lgkmcnt(5)
    v_mfma_f32_16x16x32_bf16 v[64:67], a[232:235], a[60:63], v[64:67]
    ds_read_b128 a[96:99], v20 offset:24576
    v_mfma_f32_16x16x32_bf16 v[64:67], a[236:239], a[88:91], v[64:67]
    ds_read_b128 a[16:19], v20 offset:4096
    v_mfma_f32_16x16x32_bf16 v[68:71], a[224:227], a[8:11], v[208:211]
    ds_read_b128 a[44:47], v20 offset:11264
    v_mfma_f32_16x16x32_bf16 v[68:71], a[228:231], a[36:39], v[68:71]
    ds_read_b128 a[72:75], v20 offset:18432
    s_waitcnt lgkmcnt(6)
    v_mfma_f32_16x16x32_bf16 v[68:71], a[232:235], a[64:67], v[68:71]
    ds_read_b128 a[100:103], v20 offset:25600
    v_mfma_f32_16x16x32_bf16 v[68:71], a[236:239], a[92:95], v[68:71]
    ds_read_b128 a[20:23], v20 offset:5120
    v_mfma_f32_16x16x32_bf16 v[72:75], a[224:227], a[12:15], v[212:215]
    s_waitcnt vmcnt(17)
    ds_read_b128 a[48:51], v20 offset:12288
    s_waitcnt lgkmcnt(7)
    v_mfma_f32_16x16x32_bf16 v[72:75], a[228:231], a[40:43], v[72:75]
    buffer_load_dwordx4 v5, s[8:11], s45 offen offset:1024 nt lds
    v_mfma_f32_16x16x32_bf16 v[72:75], a[232:235], a[68:71], v[72:75]
    ds_read_b128 a[76:79], v20 offset:19456
    s_waitcnt lgkmcnt(5)
    v_mfma_f32_16x16x32_bf16 v[72:75], a[236:239], a[96:99], v[72:75]
    ds_read_b128 a[104:107], v20 offset:26624
    v_mfma_f32_16x16x32_bf16 v[76:79], a[224:227], a[16:19], v[216:219]
    ds_read_b128 a[24:27], v20 offset:6144
    v_mfma_f32_16x16x32_bf16 v[76:79], a[228:231], a[44:47], v[76:79]
    ds_read_b128 a[52:55], v20 offset:13312
    s_waitcnt lgkmcnt(5)
    v_mfma_f32_16x16x32_bf16 v[76:79], a[232:235], a[72:75], v[76:79]
    ds_read_b128 a[80:83], v20 offset:20480
    v_mfma_f32_16x16x32_bf16 v[76:79], a[236:239], a[100:103], v[76:79]
    ds_read_b128 a[108:111], v20 offset:27648
    v_mfma_f32_16x16x32_bf16 v[80:83], a[224:227], a[20:23], v[220:223]
    ds_read_b128 a[112:115], v20 offset:28672
    s_waitcnt lgkmcnt(7)
    v_mfma_f32_16x16x32_bf16 v[80:83], a[228:231], a[48:51], v[80:83]
    buffer_load_dwordx4 v6, s[8:11], s45 offen offset:2048 nt lds
    s_waitcnt lgkmcnt(6)
    v_mfma_f32_16x16x32_bf16 v[80:83], a[232:235], a[76:79], v[80:83]
    ds_read_b128 a[240:243], v8 offset:12288
    ds_read_b128 a[244:247], v9 offset:12288
    ds_read_b128 a[248:251], v10 offset:12288
    ds_read_b128 a[252:255], v11 offset:12288
    ds_read_b128 a[140:143], v20 offset:35840
    s_waitcnt lgkmcnt(8)
    v_mfma_f32_16x16x32_bf16 v[80:83], a[236:239], a[104:107], v[80:83]
    ds_read_b128 a[168:171], v20 offset:43008
    v_mfma_f32_16x16x32_bf16 v[84:87], a[224:227], a[24:27], v[224:227]
    ds_read_b128 a[196:199], v20 offset:50176
    v_mfma_f32_16x16x32_bf16 v[84:87], a[228:231], a[52:55], v[84:87]
    ds_read_b128 a[116:119], v20 offset:29696
    s_waitcnt lgkmcnt(8)
    v_mfma_f32_16x16x32_bf16 v[84:87], a[232:235], a[80:83], v[84:87]
    ds_read_b128 a[144:147], v20 offset:36864
    v_mfma_f32_16x16x32_bf16 v[84:87], a[236:239], a[108:111], v[84:87]
    ds_read_b128 a[172:175], v20 offset:44032
    s_waitcnt lgkmcnt(8)
    v_mfma_f32_16x16x32_bf16 v[60:63], a[240:243], a[112:115], v[60:63]
    ds_read_b128 a[200:203], v20 offset:51200
    buffer_load_dwordx4 v7, s[8:11], s45 offen offset:3072 nt lds
    s_waitcnt lgkmcnt(6)
    v_mfma_f32_16x16x32_bf16 v[60:63], a[244:247], a[140:143], v[60:63]
    s_add_u32 m0, s37, 12288
    ds_read_b128 a[120:123], v20 offset:30720
    s_add_u32 s45, s41, 73984
    s_waitcnt lgkmcnt(5)
    v_mfma_f32_16x16x32_bf16 v[60:63], a[248:251], a[168:171], v[60:63]
    ds_read_b128 a[148:151], v20 offset:37888
    v_mfma_f32_16x16x32_bf16 v[60:63], a[252:255], a[196:199], v[60:63]
    ds_read_b128 a[176:179], v20 offset:45056
    s_waitcnt lgkmcnt(5)
    v_mfma_f32_16x16x32_bf16 v[64:67], a[240:243], a[116:119], v[64:67]
    ds_read_b128 a[204:207], v20 offset:52224
    v_mfma_f32_16x16x32_bf16 v[64:67], a[244:247], a[144:147], v[64:67]
    ds_read_b128 a[124:127], v20 offset:31744
    s_waitcnt lgkmcnt(5)
    v_mfma_f32_16x16x32_bf16 v[64:67], a[248:251], a[172:175], v[64:67]
    ds_read_b128 a[152:155], v20 offset:38912
    v_mfma_f32_16x16x32_bf16 v[64:67], a[252:255], a[200:203], v[64:67]
    ds_read_b128 a[180:183], v20 offset:46080
    buffer_load_dwordx4 v4, s[8:11], s45 offen offset:0 nt lds
    s_waitcnt lgkmcnt(6)
    v_mfma_f32_16x16x32_bf16 v[68:71], a[240:243], a[120:123], v[68:71]
    ds_read_b128 a[208:211], v20 offset:53248
    s_waitcnt lgkmcnt(6)
    v_mfma_f32_16x16x32_bf16 v[68:71], a[244:247], a[148:151], v[68:71]
    ds_read_b128 a[128:131], v20 offset:32768
    s_waitcnt lgkmcnt(6)
    v_mfma_f32_16x16x32_bf16 v[68:71], a[248:251], a[176:179], v[68:71]
    ds_read_b128 a[156:159], v20 offset:39936
    s_waitcnt lgkmcnt(5)
    v_mfma_f32_16x16x32_bf16 v[68:71], a[252:255], a[204:207], v[68:71]
    ds_read_b128 a[184:187], v20 offset:47104
    v_mfma_f32_16x16x32_bf16 v[72:75], a[240:243], a[124:127], v[72:75]
    s_waitcnt vmcnt(17)
    ds_read_b128 a[212:215], v20 offset:54272
    s_waitcnt lgkmcnt(5)
    v_mfma_f32_16x16x32_bf16 v[72:75], a[244:247], a[152:155], v[72:75]
    ds_read_b128 a[132:135], v20 offset:33792
    v_mfma_f32_16x16x32_bf16 v[72:75], a[248:251], a[180:183], v[72:75]
    ds_read_b128 a[160:163], v20 offset:40960
    buffer_load_dwordx4 v5, s[8:11], s45 offen offset:1024 nt lds
    s_waitcnt lgkmcnt(5)
    v_mfma_f32_16x16x32_bf16 v[72:75], a[252:255], a[208:211], v[72:75]
    ds_read_b128 a[188:191], v20 offset:48128
    v_mfma_f32_16x16x32_bf16 v[76:79], a[240:243], a[128:131], v[76:79]
    ds_read_b128 a[216:219], v20 offset:55296
    s_waitcnt lgkmcnt(6)
    v_mfma_f32_16x16x32_bf16 v[76:79], a[244:247], a[156:159], v[76:79]
    ds_read_b128 a[136:139], v20 offset:34816
    s_waitcnt lgkmcnt(6)
    v_mfma_f32_16x16x32_bf16 v[76:79], a[248:251], a[184:187], v[76:79]
    ds_read_b128 a[164:167], v20 offset:41984
    s_waitcnt lgkmcnt(6)
    v_mfma_f32_16x16x32_bf16 v[76:79], a[252:255], a[212:215], v[76:79]
    ds_read_b128 a[192:195], v20 offset:49152
    s_waitcnt lgkmcnt(5)
    v_mfma_f32_16x16x32_bf16 v[80:83], a[240:243], a[132:135], v[80:83]
    ds_read_b128 a[220:223], v20 offset:56320
    v_mfma_f32_16x16x32_bf16 v[80:83], a[244:247], a[160:163], v[80:83]
    ds_read_b128 a[224:227], v8 offset:16384
    s_waitcnt lgkmcnt(6)
    v_mfma_f32_16x16x32_bf16 v[80:83], a[248:251], a[188:191], v[80:83]
    ds_read_b128 a[228:231], v9 offset:16384
    ds_read_b128 a[232:235], v10 offset:16384
    buffer_load_dwordx4 v6, s[8:11], s45 offen offset:2048 nt lds
    ds_read_b128 a[236:239], v11 offset:16384
    s_waitcnt lgkmcnt(7)
    v_mfma_f32_16x16x32_bf16 v[80:83], a[252:255], a[216:219], v[80:83]
    v_mfma_f32_16x16x32_bf16 v[84:87], a[240:243], a[136:139], v[84:87]
    s_waitcnt lgkmcnt(6)
    v_mfma_f32_16x16x32_bf16 v[84:87], a[244:247], a[164:167], v[84:87]
    s_waitcnt lgkmcnt(5)
    v_mfma_f32_16x16x32_bf16 v[84:87], a[248:251], a[192:195], v[84:87]
    buffer_load_dwordx4 v7, s[8:11], s45 offen offset:3072 nt lds
    s_waitcnt lgkmcnt(4)
    v_mfma_f32_16x16x32_bf16 v[84:87], a[252:255], a[220:223], v[84:87]
    s_waitcnt lgkmcnt(0)
    v_mfma_f32_16x16x32_bf16 v[144:147], a[224:227], a[0:3], v[200:203]
    s_barrier
    v_mfma_f32_16x16x32_bf16 v[144:147], a[228:231], a[28:31], v[144:147]
    s_add_u32 m0, s37, 16384
    v_exp_f32 v60, v60
    v_mfma_f32_16x16x32_bf16 v[144:147], a[232:235], a[56:59], v[144:147]
    s_add_u32 s45, s41, 131072
    v_exp_f32 v61, v61
    v_mfma_f32_16x16x32_bf16 v[144:147], a[236:239], a[84:87], v[144:147]
    v_cvt_pk_bf16_f32 v88, v60, v61
    v_mfma_f32_16x16x32_bf16 v[148:151], a[224:227], a[4:7], v[204:207]
    v_exp_f32 v62, v62
    v_mfma_f32_16x16x32_bf16 v[148:151], a[228:231], a[32:35], v[148:151]
    buffer_load_dwordx4 v4, s[8:11], s45 offen offset:0 nt lds
    v_mfma_f32_16x16x32_bf16 v[148:151], a[232:235], a[60:63], v[148:151]
    v_exp_f32 v63, v63
    v_mfma_f32_16x16x32_bf16 v[148:151], a[236:239], a[88:91], v[148:151]
    v_cvt_pk_bf16_f32 v89, v62, v63
    v_mfma_f32_16x16x32_bf16 v[152:155], a[224:227], a[8:11], v[208:211]
    v_exp_f32 v64, v64
    v_mfma_f32_16x16x32_bf16 v[152:155], a[228:231], a[36:39], v[152:155]
    v_mfma_f32_16x16x32_bf16 v[152:155], a[232:235], a[64:67], v[152:155]
    v_exp_f32 v65, v65
    v_mfma_f32_16x16x32_bf16 v[152:155], a[236:239], a[92:95], v[152:155]
    v_cvt_pk_bf16_f32 v92, v64, v65
    v_mfma_f32_16x16x32_bf16 v[156:159], a[224:227], a[12:15], v[212:215]
    s_waitcnt vmcnt(17)
    v_exp_f32 v66, v66
    v_mfma_f32_16x16x32_bf16 v[156:159], a[228:231], a[40:43], v[156:159]
    buffer_load_dwordx4 v5, s[8:11], s45 offen offset:1024 nt lds
    v_mfma_f32_16x16x32_bf16 v[156:159], a[232:235], a[68:71], v[156:159]
    v_exp_f32 v67, v67
    v_mfma_f32_16x16x32_bf16 v[156:159], a[236:239], a[96:99], v[156:159]
    ds_read_b128 a[240:243], v8 offset:20480
    v_cvt_pk_bf16_f32 v93, v66, v67
    v_mfma_f32_16x16x32_bf16 v[160:163], a[224:227], a[16:19], v[216:219]
    v_exp_f32 v68, v68
    v_mfma_f32_16x16x32_bf16 v[160:163], a[228:231], a[44:47], v[160:163]
    ds_read_b128 a[244:247], v9 offset:20480
    v_mfma_f32_16x16x32_bf16 v[160:163], a[232:235], a[72:75], v[160:163]
    v_exp_f32 v69, v69
    v_mfma_f32_16x16x32_bf16 v[160:163], a[236:239], a[100:103], v[160:163]
    ds_read_b128 a[248:251], v10 offset:20480
    v_cvt_pk_bf16_f32 v96, v68, v69
    v_mfma_f32_16x16x32_bf16 v[164:167], a[224:227], a[20:23], v[220:223]
    v_exp_f32 v70, v70
    v_mfma_f32_16x16x32_bf16 v[164:167], a[228:231], a[48:51], v[164:167]
    ds_read_b128 a[252:255], v11 offset:20480
    v_mfma_f32_16x16x32_bf16 v[164:167], a[232:235], a[76:79], v[164:167]
    v_exp_f32 v71, v71
    v_mfma_f32_16x16x32_bf16 v[164:167], a[236:239], a[104:107], v[164:167]
    buffer_load_dwordx4 v6, s[8:11], s45 offen offset:2048 nt lds
    v_mfma_f32_16x16x32_bf16 v[168:171], a[224:227], a[24:27], v[224:227]
    v_exp_f32 v72, v72
    v_mfma_f32_16x16x32_bf16 v[168:171], a[228:231], a[52:55], v[168:171]
    v_cvt_pk_bf16_f32 v97, v70, v71
    v_mfma_f32_16x16x32_bf16 v[168:171], a[232:235], a[80:83], v[168:171]
    v_exp_f32 v73, v73
    v_mfma_f32_16x16x32_bf16 v[168:171], a[236:239], a[108:111], v[168:171]
    s_waitcnt lgkmcnt(0)
    v_cvt_pk_bf16_f32 v100, v72, v73
    v_mfma_f32_16x16x32_bf16 v[144:147], a[240:243], a[112:115], v[144:147]
    v_exp_f32 v74, v74
    v_mfma_f32_16x16x32_bf16 v[144:147], a[244:247], a[140:143], v[144:147]
    buffer_load_dwordx4 v7, s[8:11], s45 offen offset:3072 nt lds
    v_mfma_f32_16x16x32_bf16 v[144:147], a[248:251], a[168:171], v[144:147]
    s_add_u32 m0, s37, 20480
    v_exp_f32 v75, v75
    v_mfma_f32_16x16x32_bf16 v[144:147], a[252:255], a[196:199], v[144:147]
    s_add_u32 s45, s41, 131328
    v_cvt_pk_bf16_f32 v101, v74, v75
    v_mov_b32 v48, 0
    v_mfma_f32_16x16x32_bf16 v[148:151], a[240:243], a[116:119], v[148:151]
    v_exp_f32 v76, v76
    v_mfma_f32_16x16x32_bf16 v[148:151], a[244:247], a[144:147], v[148:151]
    v_mov_b32 v49, 0
    v_mov_b32 v50, 0
    v_mfma_f32_16x16x32_bf16 v[148:151], a[248:251], a[172:175], v[148:151]
    v_exp_f32 v77, v77
    v_mfma_f32_16x16x32_bf16 v[148:151], a[252:255], a[200:203], v[148:151]
    buffer_load_dwordx4 v4, s[8:11], s45 offen offset:0 nt lds
    v_mfma_f32_16x16x32_bf16 v[152:155], a[240:243], a[120:123], v[152:155]
    v_exp_f32 v78, v78
    v_mfma_f32_16x16x32_bf16 v[152:155], a[244:247], a[148:151], v[152:155]
    v_cvt_pk_bf16_f32 v104, v76, v77
    v_mov_b32 v51, 0
    v_mfma_f32_16x16x32_bf16 v[152:155], a[248:251], a[176:179], v[152:155]
    v_exp_f32 v79, v79
    v_mfma_f32_16x16x32_bf16 v[152:155], a[252:255], a[204:207], v[152:155]
    v_cvt_pk_bf16_f32 v105, v78, v79
    v_mfma_f32_16x16x32_bf16 v[156:159], a[240:243], a[124:127], v[156:159]
    s_waitcnt vmcnt(17)
    v_exp_f32 v80, v80
    v_mfma_f32_16x16x32_bf16 v[156:159], a[244:247], a[152:155], v[156:159]
    buffer_load_dwordx4 v5, s[8:11], s45 offen offset:1024 nt lds
    v_mfma_f32_16x16x32_bf16 v[156:159], a[248:251], a[180:183], v[156:159]
    v_exp_f32 v81, v81
    v_mfma_f32_16x16x32_bf16 v[156:159], a[252:255], a[208:211], v[156:159]
    ds_read_b128 a[224:227], v8 offset:0
    v_cvt_pk_bf16_f32 v108, v80, v81
    v_mfma_f32_16x16x32_bf16 v[160:163], a[240:243], a[128:131], v[160:163]
    v_exp_f32 v82, v82
    v_mfma_f32_16x16x32_bf16 v[160:163], a[244:247], a[156:159], v[160:163]
    ds_read_b128 a[228:231], v9 offset:0
    v_mfma_f32_16x16x32_bf16 v[160:163], a[248:251], a[184:187], v[160:163]
    v_exp_f32 v83, v83
    v_mfma_f32_16x16x32_bf16 v[160:163], a[252:255], a[212:215], v[160:163]
    ds_read_b128 a[232:235], v10 offset:0
    v_cvt_pk_bf16_f32 v109, v82, v83
    v_mfma_f32_16x16x32_bf16 v[164:167], a[240:243], a[132:135], v[164:167]
    v_exp_f32 v84, v84
    v_mfma_f32_16x16x32_bf16 v[164:167], a[244:247], a[160:163], v[164:167]
    ds_read_b128 a[236:239], v11 offset:0
    v_mfma_f32_16x16x32_bf16 v[164:167], a[248:251], a[188:191], v[164:167]
    v_exp_f32 v85, v85
    v_mfma_f32_16x16x32_bf16 v[164:167], a[252:255], a[216:219], v[164:167]
    buffer_load_dwordx4 v6, s[8:11], s45 offen offset:2048 nt lds
    v_mfma_f32_16x16x32_bf16 v[168:171], a[240:243], a[136:139], v[168:171]
    v_exp_f32 v86, v86
    v_mfma_f32_16x16x32_bf16 v[168:171], a[244:247], a[164:167], v[168:171]
    v_cvt_pk_bf16_f32 v112, v84, v85
    v_mfma_f32_16x16x32_bf16 v[168:171], a[248:251], a[192:195], v[168:171]
    v_exp_f32 v87, v87
    v_mfma_f32_16x16x32_bf16 v[168:171], a[252:255], a[220:223], v[168:171]
    s_waitcnt lgkmcnt(0)
    v_cvt_pk_bf16_f32 v113, v86, v87
    v_mfma_f32_16x16x32_bf16 v[60:63], a[224:227], a[0:3], v[200:203]
    buffer_load_dwordx4 v7, s[8:11], s45 offen offset:3072 nt lds
    v_mfma_f32_16x16x32_bf16 v[60:63], a[228:231], a[28:31], v[60:63]
    s_lshl_b32 s53, s64, 7
    v_exp_f32 v144, v144
    v_mfma_f32_16x16x32_bf16 v[60:63], a[232:235], a[56:59], v[60:63]
    v_exp_f32 v145, v145
    v_mfma_f32_16x16x32_bf16 v[60:63], a[236:239], a[84:87], v[60:63]
    buffer_store_dwordx4 v[48:51], v1, s[32:35], s65 offen offset:0 sc1
    v_mfma_f32_16x16x32_bf16 v[64:67], a[224:227], a[4:7], v[204:207]
    s_add_u32 m0, s37, 0
    v_exp_f32 v146, v146
    v_mfma_f32_16x16x32_bf16 v[64:67], a[228:231], a[32:35], v[64:67]
    s_add_u32 s45, s41, 139264
    v_cvt_pk_bf16_f32 v90, v144, v145
    v_mfma_f32_16x16x32_bf16 v[64:67], a[232:235], a[60:63], v[64:67]
    v_exp_f32 v147, v147
    v_mfma_f32_16x16x32_bf16 v[64:67], a[236:239], a[88:91], v[64:67]
    buffer_load_dwordx4 v4, s[8:11], s45 offen offset:0 nt lds
    v_mfma_f32_16x16x32_bf16 v[68:71], a[224:227], a[8:11], v[208:211]
    v_exp_f32 v148, v148
    v_mfma_f32_16x16x32_bf16 v[68:71], a[228:231], a[36:39], v[68:71]
    v_cvt_pk_bf16_f32 v91, v146, v147
    v_mfma_f32_16x16x32_bf16 v[68:71], a[232:235], a[64:67], v[68:71]
    v_exp_f32 v149, v149
    v_mfma_f32_16x16x32_bf16 v[68:71], a[236:239], a[92:95], v[68:71]
    ds_write_b128 v21, v[88:91] offset:0
    v_mfma_f32_16x16x32_bf16 v[72:75], a[224:227], a[12:15], v[212:215]
    s_waitcnt vmcnt(18)
    v_exp_f32 v150, v150
    v_mfma_f32_16x16x32_bf16 v[72:75], a[228:231], a[40:43], v[72:75]
    v_cvt_pk_bf16_f32 v94, v148, v149
    v_mfma_f32_16x16x32_bf16 v[72:75], a[232:235], a[68:71], v[72:75]
    v_exp_f32 v151, v151
    v_mfma_f32_16x16x32_bf16 v[72:75], a[236:239], a[96:99], v[72:75]
    buffer_load_dwordx4 v5, s[8:11], s45 offen offset:1024 nt lds
    v_mfma_f32_16x16x32_bf16 v[76:79], a[224:227], a[16:19], v[216:219]
    v_exp_f32 v152, v152
    v_mfma_f32_16x16x32_bf16 v[76:79], a[228:231], a[44:47], v[76:79]
    ds_read_b128 a[240:243], v8 offset:4096
    v_cvt_pk_bf16_f32 v95, v150, v151
    v_mfma_f32_16x16x32_bf16 v[76:79], a[232:235], a[72:75], v[76:79]
    v_exp_f32 v153, v153
    v_mfma_f32_16x16x32_bf16 v[76:79], a[236:239], a[100:103], v[76:79]
    ds_read_b128 a[244:247], v9 offset:4096
    v_mfma_f32_16x16x32_bf16 v[80:83], a[224:227], a[20:23], v[220:223]
    v_exp_f32 v154, v154
    v_mfma_f32_16x16x32_bf16 v[80:83], a[228:231], a[48:51], v[80:83]
    ds_read_b128 a[248:251], v10 offset:4096
    v_mfma_f32_16x16x32_bf16 v[80:83], a[232:235], a[76:79], v[80:83]
    ds_read_b128 a[252:255], v11 offset:4096
    v_exp_f32 v155, v155
    v_mfma_f32_16x16x32_bf16 v[80:83], a[236:239], a[104:107], v[80:83]
    buffer_load_dwordx4 v6, s[8:11], s45 offen offset:2048 nt lds
    v_mfma_f32_16x16x32_bf16 v[84:87], a[224:227], a[24:27], v[224:227]
    v_exp_f32 v156, v156
    v_mfma_f32_16x16x32_bf16 v[84:87], a[228:231], a[52:55], v[84:87]
    ds_write_b128 v21, v[92:95] offset:1024
    v_mfma_f32_16x16x32_bf16 v[84:87], a[232:235], a[80:83], v[84:87]
    v_exp_f32 v157, v157
    v_cvt_pk_bf16_f32 v98, v152, v153
    v_mfma_f32_16x16x32_bf16 v[84:87], a[236:239], a[108:111], v[84:87]
    s_waitcnt lgkmcnt(1)
    v_cvt_pk_bf16_f32 v99, v154, v155
    v_mfma_f32_16x16x32_bf16 v[60:63], a[240:243], a[112:115], v[60:63]
    v_exp_f32 v158, v158
    v_mfma_f32_16x16x32_bf16 v[60:63], a[244:247], a[140:143], v[60:63]
    buffer_load_dwordx4 v7, s[8:11], s45 offen offset:3072 nt lds
    v_mfma_f32_16x16x32_bf16 v[60:63], a[248:251], a[168:171], v[60:63]
    v_exp_f32 v159, v159
    v_mfma_f32_16x16x32_bf16 v[60:63], a[252:255], a[196:199], v[60:63]
    ds_write_b128 v21, v[96:99] offset:2048
    v_mfma_f32_16x16x32_bf16 v[64:67], a[240:243], a[116:119], v[64:67]
    s_add_u32 m0, s37, 4096
    v_exp_f32 v160, v160
    v_mfma_f32_16x16x32_bf16 v[64:67], a[244:247], a[144:147], v[64:67]
    s_add_u32 s45, s41, 139520
    v_cvt_pk_bf16_f32 v102, v156, v157
    v_cvt_pk_bf16_f32 v103, v158, v159
    v_mfma_f32_16x16x32_bf16 v[64:67], a[248:251], a[172:175], v[64:67]
    v_exp_f32 v161, v161
    v_mfma_f32_16x16x32_bf16 v[64:67], a[252:255], a[200:203], v[64:67]
    ds_write_b128 v21, v[100:103] offset:3072
    v_mfma_f32_16x16x32_bf16 v[68:71], a[240:243], a[120:123], v[68:71]
    v_exp_f32 v162, v162
    v_mfma_f32_16x16x32_bf16 v[68:71], a[244:247], a[148:151], v[68:71]
    buffer_load_dwordx4 v4, s[8:11], s45 offen offset:0 nt lds
    v_mfma_f32_16x16x32_bf16 v[68:71], a[248:251], a[176:179], v[68:71]
    v_exp_f32 v163, v163
    v_mfma_f32_16x16x32_bf16 v[68:71], a[252:255], a[204:207], v[68:71]
    v_cvt_pk_bf16_f32 v106, v160, v161
    v_cvt_pk_bf16_f32 v107, v162, v163
    v_mfma_f32_16x16x32_bf16 v[72:75], a[240:243], a[124:127], v[72:75]
    s_waitcnt vmcnt(18)
    v_exp_f32 v164, v164
    v_mfma_f32_16x16x32_bf16 v[72:75], a[244:247], a[152:155], v[72:75]
    ds_read_b128 a[224:227], v8 offset:8192
    v_mfma_f32_16x16x32_bf16 v[72:75], a[248:251], a[180:183], v[72:75]
    v_exp_f32 v165, v165
    v_mfma_f32_16x16x32_bf16 v[72:75], a[252:255], a[208:211], v[72:75]
    buffer_load_dwordx4 v5, s[8:11], s45 offen offset:1024 nt lds
    v_mfma_f32_16x16x32_bf16 v[76:79], a[240:243], a[128:131], v[76:79]
    v_exp_f32 v166, v166
    v_mfma_f32_16x16x32_bf16 v[76:79], a[244:247], a[156:159], v[76:79]
    ds_read_b128 a[228:231], v9 offset:8192
    v_mfma_f32_16x16x32_bf16 v[76:79], a[248:251], a[184:187], v[76:79]
    v_exp_f32 v167, v167
    v_mfma_f32_16x16x32_bf16 v[76:79], a[252:255], a[212:215], v[76:79]
    ds_read_b128 a[232:235], v10 offset:8192
    v_mfma_f32_16x16x32_bf16 v[80:83], a[240:243], a[132:135], v[80:83]
    v_exp_f32 v168, v168
    v_mfma_f32_16x16x32_bf16 v[80:83], a[244:247], a[160:163], v[80:83]
    ds_read_b128 a[236:239], v11 offset:8192
    v_mfma_f32_16x16x32_bf16 v[80:83], a[248:251], a[188:191], v[80:83]
    ds_write_b128 v21, v[104:107] offset:4096
    v_exp_f32 v169, v169
    v_cvt_pk_bf16_f32 v110, v164, v165
    v_mfma_f32_16x16x32_bf16 v[80:83], a[252:255], a[216:219], v[80:83]
    buffer_load_dwordx4 v6, s[8:11], s45 offen offset:2048 nt lds
    v_mfma_f32_16x16x32_bf16 v[84:87], a[240:243], a[136:139], v[84:87]
    v_exp_f32 v170, v170
    v_mfma_f32_16x16x32_bf16 v[84:87], a[244:247], a[164:167], v[84:87]
    v_cvt_pk_bf16_f32 v111, v166, v167
    v_mfma_f32_16x16x32_bf16 v[84:87], a[248:251], a[192:195], v[84:87]
    v_exp_f32 v171, v171
    v_mfma_f32_16x16x32_bf16 v[84:87], a[252:255], a[220:223], v[84:87]
    s_waitcnt lgkmcnt(1)
    ds_write_b128 v21, v[108:111] offset:5120
    v_mfma_f32_16x16x32_bf16 v[144:147], a[224:227], a[0:3], v[200:203]
    v_cvt_pk_bf16_f32 v114, v168, v169
    v_cvt_pk_bf16_f32 v115, v170, v171
    v_mfma_f32_16x16x32_bf16 v[144:147], a[228:231], a[28:31], v[144:147]
    v_exp_f32 v60, v60
    v_mfma_f32_16x16x32_bf16 v[144:147], a[232:235], a[56:59], v[144:147]
    buffer_load_dwordx4 v7, s[8:11], s45 offen offset:3072 nt lds
    v_mfma_f32_16x16x32_bf16 v[144:147], a[236:239], a[84:87], v[144:147]
    v_exp_f32 v61, v61
    v_mfma_f32_16x16x32_bf16 v[148:151], a[224:227], a[4:7], v[204:207]
    s_add_u32 m0, s37, 8192
    s_add_u32 s45, s41, 196608
    v_mfma_f32_16x16x32_bf16 v[148:151], a[228:231], a[32:35], v[148:151]
    v_exp_f32 v62, v62
    v_mfma_f32_16x16x32_bf16 v[148:151], a[232:235], a[60:63], v[148:151]
    ds_write_b128 v21, v[112:115] offset:6144
    v_mfma_f32_16x16x32_bf16 v[148:151], a[236:239], a[88:91], v[148:151]
    v_exp_f32 v63, v63
    v_mfma_f32_16x16x32_bf16 v[152:155], a[224:227], a[8:11], v[208:211]
    buffer_load_dwordx4 v4, s[8:11], s45 offen offset:0 nt lds
    v_mfma_f32_16x16x32_bf16 v[152:155], a[228:231], a[36:39], v[152:155]
    v_exp_f32 v64, v64
    v_mfma_f32_16x16x32_bf16 v[152:155], a[232:235], a[64:67], v[152:155]
    v_cvt_pk_bf16_f32 v116, v60, v61
    v_cvt_pk_bf16_f32 v117, v62, v63
    v_mfma_f32_16x16x32_bf16 v[152:155], a[236:239], a[92:95], v[152:155]
    s_add_u32 s54, s53, 128
    s_cmp_eq_u32 s54, 896
    s_cselect_b32 s54, 0, s54
    v_mfma_f32_16x16x32_bf16 v[156:159], a[224:227], a[12:15], v[212:215]
    v_exp_f32 v65, v65
    v_mfma_f32_16x16x32_bf16 v[156:159], a[228:231], a[40:43], v[156:159]
    v_cvt_pk_bf16_f32 v120, v64, v65
    v_mfma_f32_16x16x32_bf16 v[156:159], a[232:235], a[68:71], v[156:159]
    v_exp_f32 v66, v66
    v_mfma_f32_16x16x32_bf16 v[156:159], a[236:239], a[96:99], v[156:159]
    s_add_u32 s55, s54, 128
    s_cmp_eq_u32 s55, 896
    s_cselect_b32 s55, 0, s55
    v_mfma_f32_16x16x32_bf16 v[28:31], v[228:231], v[88:91], 0
    v_exp_f32 v67, v67
    v_mfma_f32_16x16x32_bf16 v[28:31], v[232:235], v[92:95], v[28:31]
    buffer_load_dwordx4 v5, s[8:11], s45 offen offset:1024 nt lds
    v_mfma_f32_16x16x32_bf16 v[28:31], v[236:239], v[96:99], v[28:31]
    v_exp_f32 v68, v68
    v_mfma_f32_16x16x32_bf16 v[28:31], v[240:243], v[100:103], v[28:31]
    s_waitcnt vmcnt(19)
    ds_read_b128 a[240:243], v8 offset:12288
    v_cvt_pk_bf16_f32 v121, v66, v67
    v_mfma_f32_16x16x32_bf16 v[28:31], v[244:247], v[104:107], v[28:31]
    v_exp_f32 v69, v69
    v_mfma_f32_16x16x32_bf16 v[28:31], v[248:251], v[108:111], v[28:31]
    ds_read_b128 a[244:247], v9 offset:12288
    v_cvt_pk_bf16_f32 v124, v68, v69
    v_mfma_f32_16x16x32_bf16 v[28:31], v[252:255], v[112:115], v[28:31]
    ds_read_b128 a[248:251], v10 offset:12288
    v_mfma_f32_16x16x32_bf16 v[160:163], a[224:227], a[16:19], v[216:219]
    v_exp_f32 v70, v70
    v_mfma_f32_16x16x32_bf16 v[160:163], a[228:231], a[44:47], v[160:163]
    buffer_load_dwordx4 v6, s[8:11], s45 offen offset:2048 nt lds
    v_mfma_f32_16x16x32_bf16 v[160:163], a[232:235], a[72:75], v[160:163]
    v_exp_f32 v71, v71
    v_mfma_f32_16x16x32_bf16 v[160:163], a[236:239], a[100:103], v[160:163]
    ds_read_b128 a[252:255], v11 offset:12288
    v_cvt_pk_bf16_f32 v125, v70, v71
    v_mfma_f32_16x16x32_bf16 v[164:167], a[224:227], a[20:23], v[220:223]
    v_exp_f32 v72, v72
    v_mfma_f32_16x16x32_bf16 v[164:167], a[228:231], a[48:51], v[164:167]
    s_add_u32 s56, s55, 128
    s_cmp_eq_u32 s56, 896
    s_cselect_b32 s56, 0, s56
    v_mfma_f32_16x16x32_bf16 v[164:167], a[232:235], a[76:79], v[164:167]
    v_exp_f32 v73, v73
    v_mfma_f32_16x16x32_bf16 v[164:167], a[236:239], a[104:107], v[164:167]
    buffer_load_dwordx4 v7, s[8:11], s45 offen offset:3072 nt lds
    v_mfma_f32_16x16x32_bf16 v[168:171], a[224:227], a[24:27], v[224:227]
    v_cvt_pk_bf16_f32 v128, v72, v73
    v_mfma_f32_16x16x32_bf16 v[168:171], a[228:231], a[52:55], v[168:171]
    v_exp_f32 v74, v74
    v_mfma_f32_16x16x32_bf16 v[168:171], a[232:235], a[80:83], v[168:171]
    s_add_u32 s57, s56, 128
    s_cmp_eq_u32 s57, 896
    s_cselect_b32 s57, 0, s57
    v_mfma_f32_16x16x32_bf16 v[168:171], a[236:239], a[108:111], v[168:171]
    s_waitcnt lgkmcnt(0)
    v_exp_f32 v75, v75
    v_mfma_f32_16x16x32_bf16 v[144:147], a[240:243], a[112:115], v[144:147]
    s_add_u32 m0, s37, 12288
    s_add_u32 s45, s41, 196864
    v_cvt_pk_bf16_f32 v129, v74, v75
    v_mfma_f32_16x16x32_bf16 v[144:147], a[244:247], a[140:143], v[144:147]
    v_exp_f32 v76, v76
    v_mfma_f32_16x16x32_bf16 v[144:147], a[248:251], a[168:171], v[144:147]
    s_add_u32 s58, s57, 128
    s_cmp_eq_u32 s58, 896
    s_cselect_b32 s58, 0, s58
    v_mfma_f32_16x16x32_bf16 v[144:147], a[252:255], a[196:199], v[144:147]
    v_exp_f32 v77, v77
    v_mfma_f32_16x16x32_bf16 v[148:151], a[240:243], a[116:119], v[148:151]
    buffer_load_dwordx4 v4, s[8:11], s45 offen offset:0 nt lds
    v_mfma_f32_16x16x32_bf16 v[148:151], a[244:247], a[144:147], v[148:151]
    v_exp_f32 v78, v78
    v_mfma_f32_16x16x32_bf16 v[148:151], a[248:251], a[172:175], v[148:151]
    v_cvt_pk_bf16_f32 v132, v76, v77
    v_mfma_f32_16x16x32_bf16 v[148:151], a[252:255], a[200:203], v[148:151]
    s_add_u32 s59, s58, 128
    s_cmp_eq_u32 s59, 896
    s_cselect_b32 s59, 0, s59
    v_mfma_f32_16x16x32_bf16 v[152:155], a[240:243], a[120:123], v[152:155]
    v_exp_f32 v79, v79
    v_mfma_f32_16x16x32_bf16 v[152:155], a[244:247], a[148:151], v[152:155]
    v_cvt_pk_bf16_f32 v133, v78, v79
    v_mfma_f32_16x16x32_bf16 v[152:155], a[248:251], a[176:179], v[152:155]
    v_exp_f32 v80, v80
    v_mfma_f32_16x16x32_bf16 v[152:155], a[252:255], a[204:207], v[152:155]
    buffer_load_dwordx4 v5, s[8:11], s45 offen offset:1024 nt lds
    v_mfma_f32_16x16x32_bf16 v[156:159], a[240:243], a[124:127], v[156:159]
    s_waitcnt vmcnt(19)
    v_exp_f32 v81, v81
    v_mfma_f32_16x16x32_bf16 v[156:159], a[244:247], a[152:155], v[156:159]
    ds_read_b128 a[224:227], v8 offset:16384
    v_cvt_pk_bf16_f32 v136, v80, v81
    v_mfma_f32_16x16x32_bf16 v[156:159], a[248:251], a[180:183], v[156:159]
    v_exp_f32 v82, v82
    v_mfma_f32_16x16x32_bf16 v[156:159], a[252:255], a[208:211], v[156:159]
    ds_read_b128 a[228:231], v9 offset:16384
    v_mfma_f32_16x16x32_bf16 v[160:163], a[240:243], a[128:131], v[160:163]
    v_exp_f32 v83, v83
    v_mfma_f32_16x16x32_bf16 v[160:163], a[244:247], a[156:159], v[160:163]
    ds_read_b128 a[232:235], v10 offset:16384
    v_cvt_pk_bf16_f32 v137, v82, v83
    v_mfma_f32_16x16x32_bf16 v[160:163], a[248:251], a[184:187], v[160:163]
    buffer_load_dwordx4 v6, s[8:11], s45 offen offset:2048 nt lds
    v_mfma_f32_16x16x32_bf16 v[160:163], a[252:255], a[212:215], v[160:163]
    v_exp_f32 v84, v84
    v_mfma_f32_16x16x32_bf16 v[164:167], a[240:243], a[132:135], v[164:167]
    ds_read_b128 a[236:239], v11 offset:16384
    v_mfma_f32_16x16x32_bf16 v[164:167], a[244:247], a[160:163], v[164:167]
    v_exp_f32 v85, v85
    v_mfma_f32_16x16x32_bf16 v[164:167], a[248:251], a[188:191], v[164:167]
    v_cvt_pk_bf16_f32 v140, v84, v85
    v_mfma_f32_16x16x32_bf16 v[164:167], a[252:255], a[216:219], v[164:167]
    v_exp_f32 v86, v86
    v_mfma_f32_16x16x32_bf16 v[168:171], a[240:243], a[136:139], v[168:171]
    v_mfma_f32_16x16x32_bf16 v[168:171], a[244:247], a[164:167], v[168:171]
    v_exp_f32 v87, v87
    v_mfma_f32_16x16x32_bf16 v[168:171], a[248:251], a[192:195], v[168:171]
    buffer_load_dwordx4 v7, s[8:11], s45 offen offset:3072 nt lds
    v_mfma_f32_16x16x32_bf16 v[168:171], a[252:255], a[220:223], v[168:171]
    s_waitcnt lgkmcnt(0)
    v_cvt_pk_bf16_f32 v141, v86, v87
    v_mfma_f32_16x16x32_bf16 v[60:63], a[224:227], a[0:3], v[200:203]
    s_add_u32 m0, s37, 16384
    s_add_u32 s45, s41, 204800
    v_mfma_f32_16x16x32_bf16 v[60:63], a[228:231], a[28:31], v[60:63]
    v_exp_f32 v144, v144
    v_mfma_f32_16x16x32_bf16 v[60:63], a[232:235], a[56:59], v[60:63]
    v_exp_f32 v145, v145
    v_mfma_f32_16x16x32_bf16 v[60:63], a[236:239], a[84:87], v[60:63]
    v_cvt_pk_bf16_f32 v118, v144, v145
    v_mfma_f32_16x16x32_bf16 v[64:67], a[224:227], a[4:7], v[204:207]
    v_exp_f32 v146, v146
    v_mfma_f32_16x16x32_bf16 v[64:67], a[228:231], a[32:35], v[64:67]
    buffer_load_dwordx4 v4, s[8:11], s45 offen offset:0 nt lds
    v_mfma_f32_16x16x32_bf16 v[64:67], a[232:235], a[60:63], v[64:67]
    v_exp_f32 v147, v147
    v_mfma_f32_16x16x32_bf16 v[64:67], a[236:239], a[88:91], v[64:67]
    v_cvt_pk_bf16_f32 v119, v146, v147
    v_mfma_f32_16x16x32_bf16 v[68:71], a[224:227], a[8:11], v[208:211]
    v_exp_f32 v148, v148
    v_mfma_f32_16x16x32_bf16 v[68:71], a[228:231], a[36:39], v[68:71]
    ds_write_b128 v21, v[116:119] offset:28672
    v_mfma_f32_16x16x32_bf16 v[68:71], a[232:235], a[64:67], v[68:71]
    v_exp_f32 v149, v149
    v_mfma_f32_16x16x32_bf16 v[68:71], a[236:239], a[92:95], v[68:71]
    v_cvt_pk_bf16_f32 v122, v148, v149
    v_mfma_f32_16x16x32_bf16 v[72:75], a[224:227], a[12:15], v[212:215]
    s_waitcnt vmcnt(18)
    v_exp_f32 v150, v150
    v_mfma_f32_16x16x32_bf16 v[72:75], a[228:231], a[40:43], v[72:75]
    buffer_load_dwordx4 v5, s[8:11], s45 offen offset:1024 nt lds
    v_mfma_f32_16x16x32_bf16 v[72:75], a[232:235], a[68:71], v[72:75]
    v_exp_f32 v151, v151
    v_mfma_f32_16x16x32_bf16 v[72:75], a[236:239], a[96:99], v[72:75]
    ds_read_b128 a[240:243], v8 offset:20480
    v_cvt_pk_bf16_f32 v123, v150, v151
    v_mfma_f32_16x16x32_bf16 v[76:79], a[224:227], a[16:19], v[216:219]
    v_exp_f32 v152, v152
    v_mfma_f32_16x16x32_bf16 v[76:79], a[228:231], a[44:47], v[76:79]
    ds_read_b128 a[244:247], v9 offset:20480
    v_mfma_f32_16x16x32_bf16 v[76:79], a[232:235], a[72:75], v[76:79]
    v_exp_f32 v153, v153
    v_mfma_f32_16x16x32_bf16 v[76:79], a[236:239], a[100:103], v[76:79]
    ds_read_b128 a[248:251], v10 offset:20480
    v_mfma_f32_16x16x32_bf16 v[80:83], a[224:227], a[20:23], v[220:223]
    v_exp_f32 v154, v154
    v_mfma_f32_16x16x32_bf16 v[80:83], a[228:231], a[48:51], v[80:83]
    ds_read_b128 a[252:255], v11 offset:20480
    v_mfma_f32_16x16x32_bf16 v[80:83], a[232:235], a[76:79], v[80:83]
    buffer_load_dwordx4 v6, s[8:11], s45 offen offset:2048 nt lds
    v_exp_f32 v155, v155
    v_mfma_f32_16x16x32_bf16 v[80:83], a[236:239], a[104:107], v[80:83]
    ds_write_b128 v21, v[120:123] offset:29696
    v_mfma_f32_16x16x32_bf16 v[84:87], a[224:227], a[24:27], v[224:227]
    v_exp_f32 v156, v156
    v_mfma_f32_16x16x32_bf16 v[84:87], a[228:231], a[52:55], v[84:87]
    v_cvt_pk_bf16_f32 v126, v152, v153
    v_cvt_pk_bf16_f32 v127, v154, v155
    v_mfma_f32_16x16x32_bf16 v[84:87], a[232:235], a[80:83], v[84:87]
    v_exp_f32 v157, v157
    v_mfma_f32_16x16x32_bf16 v[84:87], a[236:239], a[108:111], v[84:87]
    s_waitcnt lgkmcnt(1)
    ds_write_b128 v21, v[124:127] offset:30720
    v_mfma_f32_16x16x32_bf16 v[60:63], a[240:243], a[112:115], v[60:63]
    v_exp_f32 v158, v158
    v_mfma_f32_16x16x32_bf16 v[60:63], a[244:247], a[140:143], v[60:63]
    buffer_load_dwordx4 v7, s[8:11], s45 offen offset:3072 nt lds
    v_mfma_f32_16x16x32_bf16 v[60:63], a[248:251], a[168:171], v[60:63]
    s_add_u32 m0, s37, 20480
    v_exp_f32 v159, v159
    v_mfma_f32_16x16x32_bf16 v[60:63], a[252:255], a[196:199], v[60:63]
    s_add_u32 s45, s41, 205056
    v_cvt_pk_bf16_f32 v130, v156, v157
    v_cvt_pk_bf16_f32 v131, v158, v159
    v_mfma_f32_16x16x32_bf16 v[64:67], a[240:243], a[116:119], v[64:67]
    v_exp_f32 v160, v160
    v_mfma_f32_16x16x32_bf16 v[64:67], a[244:247], a[144:147], v[64:67]
    buffer_load_dwordx4 v4, s[8:11], s45 offen offset:0 nt lds
    v_mfma_f32_16x16x32_bf16 v[64:67], a[248:251], a[172:175], v[64:67]
    v_exp_f32 v161, v161
    v_mfma_f32_16x16x32_bf16 v[64:67], a[252:255], a[200:203], v[64:67]
    ds_write_b128 v21, v[128:131] offset:31744
    v_mfma_f32_16x16x32_bf16 v[68:71], a[240:243], a[120:123], v[68:71]
    v_exp_f32 v162, v162
    v_mfma_f32_16x16x32_bf16 v[68:71], a[244:247], a[148:151], v[68:71]
    v_cvt_pk_bf16_f32 v134, v160, v161
    v_mfma_f32_16x16x32_bf16 v[68:71], a[248:251], a[176:179], v[68:71]
    v_exp_f32 v163, v163
    v_mfma_f32_16x16x32_bf16 v[68:71], a[252:255], a[204:207], v[68:71]
    v_cvt_pk_bf16_f32 v135, v162, v163
    v_mfma_f32_16x16x32_bf16 v[72:75], a[240:243], a[124:127], v[72:75]
    s_waitcnt vmcnt(17)
    v_exp_f32 v164, v164
    v_mfma_f32_16x16x32_bf16 v[72:75], a[244:247], a[152:155], v[72:75]
    buffer_load_dwordx4 v5, s[8:11], s45 offen offset:1024 nt lds
    v_mfma_f32_16x16x32_bf16 v[72:75], a[248:251], a[180:183], v[72:75]
    v_exp_f32 v165, v165
    v_mfma_f32_16x16x32_bf16 v[72:75], a[252:255], a[208:211], v[72:75]
    ds_read_b128 a[224:227], v8 offset:0
    v_mfma_f32_16x16x32_bf16 v[76:79], a[240:243], a[128:131], v[76:79]
    v_exp_f32 v166, v166
    v_mfma_f32_16x16x32_bf16 v[76:79], a[244:247], a[156:159], v[76:79]
    ds_read_b128 a[228:231], v9 offset:0
    v_mfma_f32_16x16x32_bf16 v[76:79], a[248:251], a[184:187], v[76:79]
    v_exp_f32 v167, v167
    v_mfma_f32_16x16x32_bf16 v[76:79], a[252:255], a[212:215], v[76:79]
    ds_read_b128 a[232:235], v10 offset:0
    v_mfma_f32_16x16x32_bf16 v[80:83], a[240:243], a[132:135], v[80:83]
    v_exp_f32 v168, v168
    v_mfma_f32_16x16x32_bf16 v[80:83], a[244:247], a[160:163], v[80:83]
    ds_read_b128 a[236:239], v11 offset:0
    v_mfma_f32_16x16x32_bf16 v[80:83], a[248:251], a[188:191], v[80:83]
    ds_write_b128 v21, v[132:135] offset:32768
    v_exp_f32 v169, v169
    v_cvt_pk_bf16_f32 v138, v164, v165
    v_mfma_f32_16x16x32_bf16 v[80:83], a[252:255], a[216:219], v[80:83]
    buffer_load_dwordx4 v6, s[8:11], s45 offen offset:2048 nt lds
    v_mfma_f32_16x16x32_bf16 v[84:87], a[240:243], a[136:139], v[84:87]
    v_exp_f32 v170, v170
    v_mfma_f32_16x16x32_bf16 v[84:87], a[244:247], a[164:167], v[84:87]
    v_cvt_pk_bf16_f32 v139, v166, v167
    v_mfma_f32_16x16x32_bf16 v[84:87], a[248:251], a[192:195], v[84:87]
    v_exp_f32 v171, v171
    v_mfma_f32_16x16x32_bf16 v[84:87], a[252:255], a[220:223], v[84:87]
    s_waitcnt lgkmcnt(1)
    ds_write_b128 v21, v[136:139] offset:33792
    v_mfma_f32_16x16x32_bf16 v[144:147], a[224:227], a[0:3], v[200:203]
    buffer_load_dwordx4 v7, s[8:11], s45 offen offset:3072 nt lds
    v_mfma_f32_16x16x32_bf16 v[144:147], a[228:231], a[28:31], v[144:147]
    v_exp_f32 v60, v60
    v_mfma_f32_16x16x32_bf16 v[144:147], a[232:235], a[56:59], v[144:147]
    s_add_u32 m0, s37, 0
    v_cvt_pk_bf16_f32 v142, v168, v169
    v_cvt_pk_bf16_f32 v143, v170, v171
    v_mfma_f32_16x16x32_bf16 v[144:147], a[236:239], a[84:87], v[144:147]
    s_add_u32 s45, s42, 0
    v_exp_f32 v61, v61
    v_mfma_f32_16x16x32_bf16 v[148:151], a[224:227], a[4:7], v[204:207]
    ds_write_b128 v21, v[140:143] offset:34816
    v_mfma_f32_16x16x32_bf16 v[148:151], a[228:231], a[32:35], v[148:151]
    v_exp_f32 v62, v62
    v_mfma_f32_16x16x32_bf16 v[148:151], a[232:235], a[60:63], v[148:151]
    buffer_load_dwordx4 v12, s[12:15], s45 offen offset:0 nt lds
    v_mfma_f32_16x16x32_bf16 v[148:151], a[236:239], a[88:91], v[148:151]
    v_exp_f32 v63, v63
    v_mfma_f32_16x16x32_bf16 v[152:155], a[224:227], a[8:11], v[208:211]
    v_cvt_pk_bf16_f32 v172, v60, v61
    v_cvt_pk_bf16_f32 v173, v62, v63
    v_mfma_f32_16x16x32_bf16 v[152:155], a[228:231], a[36:39], v[152:155]
    v_exp_f32 v64, v64
    v_mfma_f32_16x16x32_bf16 v[152:155], a[232:235], a[64:67], v[152:155]
    v_mfma_f32_16x16x32_bf16 v[152:155], a[236:239], a[92:95], v[152:155]
    v_mfma_f32_16x16x32_bf16 v[156:159], a[224:227], a[12:15], v[212:215]
    v_exp_f32 v65, v65
    v_mfma_f32_16x16x32_bf16 v[156:159], a[228:231], a[40:43], v[156:159]
    buffer_load_dwordx4 v13, s[12:15], s45 offen offset:1024 nt lds
    v_mfma_f32_16x16x32_bf16 v[156:159], a[232:235], a[68:71], v[156:159]
    v_exp_f32 v66, v66
    v_mfma_f32_16x16x32_bf16 v[156:159], a[236:239], a[96:99], v[156:159]
    v_cvt_pk_bf16_f32 v176, v64, v65
    v_mfma_f32_16x16x32_bf16 v[28:31], v[228:231], v[116:119], v[28:31]
    v_exp_f32 v67, v67
    v_mfma_f32_16x16x32_bf16 v[28:31], v[232:235], v[120:123], v[28:31]
    v_cvt_pk_bf16_f32 v177, v66, v67
    v_mfma_f32_16x16x32_bf16 v[28:31], v[236:239], v[124:127], v[28:31]
    v_exp_f32 v68, v68
    v_mfma_f32_16x16x32_bf16 v[28:31], v[240:243], v[128:131], v[28:31]
    s_waitcnt vmcnt(18)
    ds_read_b128 a[240:243], v8 offset:4096
    v_mfma_f32_16x16x32_bf16 v[28:31], v[244:247], v[132:135], v[28:31]
    v_exp_f32 v69, v69
    v_mfma_f32_16x16x32_bf16 v[28:31], v[248:251], v[136:139], v[28:31]
    buffer_load_dwordx4 v14, s[12:15], s45 offen offset:2048 nt lds
    v_mfma_f32_16x16x32_bf16 v[28:31], v[252:255], v[140:143], v[28:31]
    ds_read_b128 a[244:247], v9 offset:4096
    v_cvt_pk_bf16_f32 v180, v68, v69
    v_mfma_f32_16x16x32_bf16 v[160:163], a[224:227], a[16:19], v[216:219]
    v_exp_f32 v70, v70
    v_mfma_f32_16x16x32_bf16 v[160:163], a[228:231], a[44:47], v[160:163]
    ds_read_b128 a[248:251], v10 offset:4096
    v_mfma_f32_16x16x32_bf16 v[160:163], a[232:235], a[72:75], v[160:163]
    v_exp_f32 v71, v71
    v_mfma_f32_16x16x32_bf16 v[160:163], a[236:239], a[100:103], v[160:163]
    ds_read_b128 a[252:255], v11 offset:4096
    v_cvt_pk_bf16_f32 v181, v70, v71
    v_mfma_f32_16x16x32_bf16 v[164:167], a[224:227], a[20:23], v[220:223]
    v_exp_f32 v72, v72
    v_mfma_f32_16x16x32_bf16 v[164:167], a[228:231], a[48:51], v[164:167]
    buffer_load_dwordx4 v15, s[12:15], s45 offen offset:3072 nt lds
    v_mfma_f32_16x16x32_bf16 v[164:167], a[232:235], a[76:79], v[164:167]
    v_exp_f32 v73, v73
    v_mfma_f32_16x16x32_bf16 v[164:167], a[236:239], a[104:107], v[164:167]
    v_cvt_pk_bf16_f32 v184, v72, v73
    v_mfma_f32_16x16x32_bf16 v[168:171], a[224:227], a[24:27], v[224:227]
    v_mfma_f32_16x16x32_bf16 v[168:171], a[228:231], a[52:55], v[168:171]
    v_exp_f32 v74, v74
    v_mfma_f32_16x16x32_bf16 v[168:171], a[232:235], a[80:83], v[168:171]
    v_mfma_f32_16x16x32_bf16 v[168:171], a[236:239], a[108:111], v[168:171]
    s_waitcnt lgkmcnt(0)
    v_exp_f32 v75, v75
    v_mfma_f32_16x16x32_bf16 v[144:147], a[240:243], a[112:115], v[144:147]
    s_add_u32 m0, s37, 4096
    s_add_u32 s45, s42, 16384
    v_cvt_pk_bf16_f32 v185, v74, v75
    v_mfma_f32_16x16x32_bf16 v[144:147], a[244:247], a[140:143], v[144:147]
    v_exp_f32 v76, v76
    v_mfma_f32_16x16x32_bf16 v[144:147], a[248:251], a[168:171], v[144:147]
    v_mfma_f32_16x16x32_bf16 v[144:147], a[252:255], a[196:199], v[144:147]
    v_exp_f32 v77, v77
    v_mfma_f32_16x16x32_bf16 v[148:151], a[240:243], a[116:119], v[148:151]
    buffer_load_dwordx4 v12, s[12:15], s45 offen offset:0 nt lds
    v_mfma_f32_16x16x32_bf16 v[148:151], a[244:247], a[144:147], v[148:151]
    v_exp_f32 v78, v78
    v_mfma_f32_16x16x32_bf16 v[148:151], a[248:251], a[172:175], v[148:151]
    v_cvt_pk_bf16_f32 v188, v76, v77
    v_mfma_f32_16x16x32_bf16 v[148:151], a[252:255], a[200:203], v[148:151]
    v_mfma_f32_16x16x32_bf16 v[152:155], a[240:243], a[120:123], v[152:155]
    v_exp_f32 v79, v79
    v_mfma_f32_16x16x32_bf16 v[152:155], a[244:247], a[148:151], v[152:155]
    v_cvt_pk_bf16_f32 v189, v78, v79
    v_mfma_f32_16x16x32_bf16 v[152:155], a[248:251], a[176:179], v[152:155]
    v_exp_f32 v80, v80
    v_mfma_f32_16x16x32_bf16 v[152:155], a[252:255], a[204:207], v[152:155]
    buffer_load_dwordx4 v13, s[12:15], s45 offen offset:1024 nt lds
    v_mfma_f32_16x16x32_bf16 v[156:159], a[240:243], a[124:127], v[156:159]
    s_waitcnt vmcnt(18)
    v_exp_f32 v81, v81
    v_mfma_f32_16x16x32_bf16 v[156:159], a[244:247], a[152:155], v[156:159]
    ds_read_b128 a[224:227], v8 offset:8192
    v_cvt_pk_bf16_f32 v192, v80, v81
    v_mfma_f32_16x16x32_bf16 v[156:159], a[248:251], a[180:183], v[156:159]
    v_exp_f32 v82, v82
    v_mfma_f32_16x16x32_bf16 v[156:159], a[252:255], a[208:211], v[156:159]
    ds_read_b128 a[228:231], v9 offset:8192
    v_mfma_f32_16x16x32_bf16 v[160:163], a[240:243], a[128:131], v[160:163]
    v_exp_f32 v83, v83
    v_mfma_f32_16x16x32_bf16 v[160:163], a[244:247], a[156:159], v[160:163]
    ds_read_b128 a[232:235], v10 offset:8192
    v_cvt_pk_bf16_f32 v193, v82, v83
    v_mfma_f32_16x16x32_bf16 v[160:163], a[248:251], a[184:187], v[160:163]
    buffer_load_dwordx4 v14, s[12:15], s45 offen offset:2048 nt lds
    v_mfma_f32_16x16x32_bf16 v[160:163], a[252:255], a[212:215], v[160:163]
    v_exp_f32 v84, v84
    v_mfma_f32_16x16x32_bf16 v[164:167], a[240:243], a[132:135], v[164:167]
    ds_read_b128 a[236:239], v11 offset:8192
    v_mov_b32 v2, 1
    v_mfma_f32_16x16x32_bf16 v[164:167], a[244:247], a[160:163], v[164:167]
    v_exp_f32 v85, v85
    v_mfma_f32_16x16x32_bf16 v[164:167], a[248:251], a[188:191], v[164:167]
    v_cvt_pk_bf16_f32 v196, v84, v85
    v_mov_b32 v1, s99
    v_mfma_f32_16x16x32_bf16 v[164:167], a[252:255], a[216:219], v[164:167]
    s_waitcnt vmcnt(31)
    v_exp_f32 v86, v86
    v_mfma_f32_16x16x32_bf16 v[168:171], a[240:243], a[136:139], v[168:171]
    v_mfma_f32_16x16x32_bf16 v[168:171], a[244:247], a[164:167], v[168:171]
    v_exp_f32 v87, v87
    v_mfma_f32_16x16x32_bf16 v[168:171], a[248:251], a[192:195], v[168:171]
    buffer_load_dwordx4 v15, s[12:15], s45 offen offset:3072 nt lds
    v_mfma_f32_16x16x32_bf16 v[168:171], a[252:255], a[220:223], v[168:171]
    s_waitcnt lgkmcnt(0)
    v_cvt_pk_bf16_f32 v197, v86, v87
    v_mfma_f32_16x16x32_bf16 v[60:63], a[224:227], a[0:3], v[200:203]
    s_add_u32 m0, s37, 8192
    s_add_u32 s45, s42, 32768
    v_mfma_f32_16x16x32_bf16 v[60:63], a[228:231], a[28:31], v[60:63]
    v_exp_f32 v144, v144
    v_mfma_f32_16x16x32_bf16 v[60:63], a[232:235], a[56:59], v[60:63]
    v_exp_f32 v145, v145
    v_mfma_f32_16x16x32_bf16 v[60:63], a[236:239], a[84:87], v[60:63]
    v_cvt_pk_bf16_f32 v174, v144, v145
    v_mfma_f32_16x16x32_bf16 v[64:67], a[224:227], a[4:7], v[204:207]
    v_exp_f32 v146, v146
    v_mfma_f32_16x16x32_bf16 v[64:67], a[228:231], a[32:35], v[64:67]
    buffer_load_dwordx4 v12, s[12:15], s45 offen offset:0 nt lds
    v_mfma_f32_16x16x32_bf16 v[64:67], a[232:235], a[60:63], v[64:67]
    v_exp_f32 v147, v147
    v_mfma_f32_16x16x32_bf16 v[64:67], a[236:239], a[88:91], v[64:67]
    buffer_store_dword v2, v1, s[28:31], 0 offen offset:0 sc1
    v_mfma_f32_16x16x32_bf16 v[68:71], a[224:227], a[8:11], v[208:211]
    v_exp_f32 v148, v148
    v_mfma_f32_16x16x32_bf16 v[68:71], a[228:231], a[36:39], v[68:71]
    v_cvt_pk_bf16_f32 v175, v146, v147
    v_mfma_f32_16x16x32_bf16 v[68:71], a[232:235], a[64:67], v[68:71]
    v_exp_f32 v149, v149
    v_mfma_f32_16x16x32_bf16 v[68:71], a[236:239], a[92:95], v[68:71]
    v_cvt_pk_bf16_f32 v178, v148, v149
    v_mfma_f32_16x16x32_bf16 v[72:75], a[224:227], a[12:15], v[212:215]
    s_waitcnt vmcnt(18)
    v_exp_f32 v150, v150
    v_mfma_f32_16x16x32_bf16 v[72:75], a[228:231], a[40:43], v[72:75]
    buffer_load_dwordx4 v13, s[12:15], s45 offen offset:1024 nt lds
    v_mfma_f32_16x16x32_bf16 v[72:75], a[232:235], a[68:71], v[72:75]
    v_exp_f32 v151, v151
    v_mfma_f32_16x16x32_bf16 v[72:75], a[236:239], a[96:99], v[72:75]
    ds_read_b128 a[240:243], v8 offset:12288
    v_cvt_pk_bf16_f32 v179, v150, v151
    v_mfma_f32_16x16x32_bf16 v[76:79], a[224:227], a[16:19], v[216:219]
    v_exp_f32 v152, v152
    v_mfma_f32_16x16x32_bf16 v[76:79], a[228:231], a[44:47], v[76:79]
    ds_read_b128 a[244:247], v9 offset:12288
    v_mfma_f32_16x16x32_bf16 v[76:79], a[232:235], a[72:75], v[76:79]
    v_exp_f32 v153, v153
    v_mfma_f32_16x16x32_bf16 v[76:79], a[236:239], a[100:103], v[76:79]
    ds_read_b128 a[248:251], v10 offset:12288
    v_cvt_pk_bf16_f32 v182, v152, v153
    v_mfma_f32_16x16x32_bf16 v[80:83], a[224:227], a[20:23], v[220:223]
    v_exp_f32 v154, v154
    v_mfma_f32_16x16x32_bf16 v[80:83], a[228:231], a[48:51], v[80:83]
    ds_read_b128 a[252:255], v11 offset:12288
    v_mfma_f32_16x16x32_bf16 v[80:83], a[232:235], a[76:79], v[80:83]
    buffer_load_dwordx4 v14, s[12:15], s45 offen offset:2048 nt lds
    v_exp_f32 v155, v155
    v_mfma_f32_16x16x32_bf16 v[80:83], a[236:239], a[104:107], v[80:83]
    v_cvt_pk_bf16_f32 v183, v154, v155
    v_mfma_f32_16x16x32_bf16 v[84:87], a[224:227], a[24:27], v[224:227]
    v_exp_f32 v156, v156
    v_mfma_f32_16x16x32_bf16 v[84:87], a[228:231], a[52:55], v[84:87]
    v_mfma_f32_16x16x32_bf16 v[84:87], a[232:235], a[80:83], v[84:87]
    v_exp_f32 v157, v157
    v_mfma_f32_16x16x32_bf16 v[84:87], a[236:239], a[108:111], v[84:87]
    s_waitcnt lgkmcnt(0)
    v_cvt_pk_bf16_f32 v186, v156, v157
    v_mfma_f32_16x16x32_bf16 v[60:63], a[240:243], a[112:115], v[60:63]
    v_exp_f32 v158, v158
    v_mfma_f32_16x16x32_bf16 v[60:63], a[244:247], a[140:143], v[60:63]
    buffer_load_dwordx4 v15, s[12:15], s45 offen offset:3072 nt lds
    v_mfma_f32_16x16x32_bf16 v[60:63], a[248:251], a[168:171], v[60:63]
    s_add_u32 m0, s37, 12288
    v_exp_f32 v159, v159
    v_mfma_f32_16x16x32_bf16 v[60:63], a[252:255], a[196:199], v[60:63]
    s_add_u32 s45, s42, 49152
    v_cvt_pk_bf16_f32 v187, v158, v159
    v_mfma_f32_16x16x32_bf16 v[64:67], a[240:243], a[116:119], v[64:67]
    v_exp_f32 v160, v160
    v_mfma_f32_16x16x32_bf16 v[64:67], a[244:247], a[144:147], v[64:67]
    buffer_load_dwordx4 v12, s[12:15], s45 offen offset:0 nt lds
    v_mfma_f32_16x16x32_bf16 v[64:67], a[248:251], a[172:175], v[64:67]
    v_exp_f32 v161, v161
    v_mfma_f32_16x16x32_bf16 v[64:67], a[252:255], a[200:203], v[64:67]
    v_cvt_pk_bf16_f32 v190, v160, v161
    v_mfma_f32_16x16x32_bf16 v[68:71], a[240:243], a[120:123], v[68:71]
    v_exp_f32 v162, v162
    v_mfma_f32_16x16x32_bf16 v[68:71], a[244:247], a[148:151], v[68:71]
    v_mfma_f32_16x16x32_bf16 v[68:71], a[248:251], a[176:179], v[68:71]
    v_exp_f32 v163, v163
    v_mfma_f32_16x16x32_bf16 v[68:71], a[252:255], a[204:207], v[68:71]
    v_cvt_pk_bf16_f32 v191, v162, v163
    v_mfma_f32_16x16x32_bf16 v[72:75], a[240:243], a[124:127], v[72:75]
    s_waitcnt vmcnt(18)
    v_exp_f32 v164, v164
    v_mfma_f32_16x16x32_bf16 v[72:75], a[244:247], a[152:155], v[72:75]
    buffer_load_dwordx4 v13, s[12:15], s45 offen offset:1024 nt lds
    v_mfma_f32_16x16x32_bf16 v[72:75], a[248:251], a[180:183], v[72:75]
    v_exp_f32 v165, v165
    v_mfma_f32_16x16x32_bf16 v[72:75], a[252:255], a[208:211], v[72:75]
    ds_read_b128 a[224:227], v8 offset:16384
    v_cvt_pk_bf16_f32 v194, v164, v165
    v_mfma_f32_16x16x32_bf16 v[76:79], a[240:243], a[128:131], v[76:79]
    v_exp_f32 v166, v166
    v_mfma_f32_16x16x32_bf16 v[76:79], a[244:247], a[156:159], v[76:79]
    ds_read_b128 a[228:231], v9 offset:16384
    v_mfma_f32_16x16x32_bf16 v[76:79], a[248:251], a[184:187], v[76:79]
    v_exp_f32 v167, v167
    v_mfma_f32_16x16x32_bf16 v[76:79], a[252:255], a[212:215], v[76:79]
    ds_read_b128 a[232:235], v10 offset:16384
    v_cvt_pk_bf16_f32 v195, v166, v167
    v_mfma_f32_16x16x32_bf16 v[80:83], a[240:243], a[132:135], v[80:83]
    v_exp_f32 v168, v168
    v_mfma_f32_16x16x32_bf16 v[80:83], a[244:247], a[160:163], v[80:83]
    ds_read_b128 a[236:239], v11 offset:16384
    v_mfma_f32_16x16x32_bf16 v[80:83], a[248:251], a[188:191], v[80:83]
    v_exp_f32 v169, v169
    v_mfma_f32_16x16x32_bf16 v[80:83], a[252:255], a[216:219], v[80:83]
    buffer_load_dwordx4 v14, s[12:15], s45 offen offset:2048 nt lds
    v_mfma_f32_16x16x32_bf16 v[84:87], a[240:243], a[136:139], v[84:87]
    v_exp_f32 v170, v170
    v_mfma_f32_16x16x32_bf16 v[84:87], a[244:247], a[164:167], v[84:87]
    v_cvt_pk_bf16_f32 v198, v168, v169
    v_mfma_f32_16x16x32_bf16 v[84:87], a[248:251], a[192:195], v[84:87]
    v_exp_f32 v171, v171
    v_mfma_f32_16x16x32_bf16 v[84:87], a[252:255], a[220:223], v[84:87]
    s_waitcnt lgkmcnt(0)
    v_cvt_pk_bf16_f32 v199, v170, v171
    v_mfma_f32_16x16x32_bf16 v[144:147], a[224:227], a[0:3], v[200:203]
    buffer_load_dwordx4 v15, s[12:15], s45 offen offset:3072 nt lds
    v_mfma_f32_16x16x32_bf16 v[144:147], a[228:231], a[28:31], v[144:147]
    v_exp_f32 v60, v60
    v_mfma_f32_16x16x32_bf16 v[144:147], a[232:235], a[56:59], v[144:147]
    s_add_u32 m0, s37, 16384
    s_add_u32 s45, s42, 65536
    v_mfma_f32_16x16x32_bf16 v[144:147], a[236:239], a[84:87], v[144:147]
    v_exp_f32 v61, v61
    v_mfma_f32_16x16x32_bf16 v[148:151], a[224:227], a[4:7], v[204:207]
    v_cvt_pk_bf16_f32 v200, v60, v61
    v_mfma_f32_16x16x32_bf16 v[148:151], a[228:231], a[32:35], v[148:151]
    v_exp_f32 v62, v62
    v_mfma_f32_16x16x32_bf16 v[148:151], a[232:235], a[60:63], v[148:151]
    buffer_load_dwordx4 v12, s[12:15], s45 offen offset:0 nt lds
    v_mfma_f32_16x16x32_bf16 v[148:151], a[236:239], a[88:91], v[148:151]
    v_exp_f32 v63, v63
    v_mfma_f32_16x16x32_bf16 v[152:155], a[224:227], a[8:11], v[208:211]
    v_cvt_pk_bf16_f32 v201, v62, v63
    v_mfma_f32_16x16x32_bf16 v[152:155], a[228:231], a[36:39], v[152:155]
    v_exp_f32 v64, v64
    v_mfma_f32_16x16x32_bf16 v[152:155], a[232:235], a[64:67], v[152:155]
    v_mfma_f32_16x16x32_bf16 v[152:155], a[236:239], a[92:95], v[152:155]
    v_mfma_f32_16x16x32_bf16 v[156:159], a[224:227], a[12:15], v[212:215]
    v_exp_f32 v65, v65
    v_mfma_f32_16x16x32_bf16 v[156:159], a[228:231], a[40:43], v[156:159]
    buffer_load_dwordx4 v13, s[12:15], s45 offen offset:1024 nt lds
    v_mfma_f32_16x16x32_bf16 v[156:159], a[232:235], a[68:71], v[156:159]
    v_exp_f32 v66, v66
    v_mfma_f32_16x16x32_bf16 v[156:159], a[236:239], a[96:99], v[156:159]
    v_cvt_pk_bf16_f32 v204, v64, v65
    v_mfma_f32_16x16x32_bf16 v[28:31], v[228:231], v[172:175], v[28:31]
    v_exp_f32 v67, v67
    v_mfma_f32_16x16x32_bf16 v[28:31], v[232:235], v[176:179], v[28:31]
    v_cvt_pk_bf16_f32 v205, v66, v67
    v_mfma_f32_16x16x32_bf16 v[28:31], v[236:239], v[180:183], v[28:31]
    v_exp_f32 v68, v68
    v_mfma_f32_16x16x32_bf16 v[28:31], v[240:243], v[184:187], v[28:31]
    s_waitcnt vmcnt(19)
    ds_read_b128 a[240:243], v8 offset:20480
    v_mfma_f32_16x16x32_bf16 v[28:31], v[244:247], v[188:191], v[28:31]
    v_exp_f32 v69, v69
    v_mfma_f32_16x16x32_bf16 v[28:31], v[248:251], v[192:195], v[28:31]
    buffer_load_dwordx4 v14, s[12:15], s45 offen offset:2048 nt lds
    v_mfma_f32_16x16x32_bf16 v[28:31], v[252:255], v[196:199], v[28:31]
    ds_read_b128 a[244:247], v9 offset:20480
    v_cvt_pk_bf16_f32 v208, v68, v69
    v_mfma_f32_16x16x32_bf16 v[160:163], a[224:227], a[16:19], v[216:219]
    v_exp_f32 v70, v70
    v_mfma_f32_16x16x32_bf16 v[160:163], a[228:231], a[44:47], v[160:163]
    ds_read_b128 a[248:251], v10 offset:20480
    v_mfma_f32_16x16x32_bf16 v[160:163], a[232:235], a[72:75], v[160:163]
    v_exp_f32 v71, v71
    v_mfma_f32_16x16x32_bf16 v[160:163], a[236:239], a[100:103], v[160:163]
    ds_read_b128 a[252:255], v11 offset:20480
    v_cvt_pk_bf16_f32 v209, v70, v71
    v_mfma_f32_16x16x32_bf16 v[164:167], a[224:227], a[20:23], v[220:223]
    v_exp_f32 v72, v72
    v_mfma_f32_16x16x32_bf16 v[164:167], a[228:231], a[48:51], v[164:167]
    buffer_load_dwordx4 v15, s[12:15], s45 offen offset:3072 nt lds
    v_mfma_f32_16x16x32_bf16 v[164:167], a[232:235], a[76:79], v[164:167]
    v_exp_f32 v73, v73
    v_mfma_f32_16x16x32_bf16 v[164:167], a[236:239], a[104:107], v[164:167]
    v_cvt_pk_bf16_f32 v212, v72, v73
    v_mfma_f32_16x16x32_bf16 v[168:171], a[224:227], a[24:27], v[224:227]
    v_mfma_f32_16x16x32_bf16 v[168:171], a[228:231], a[52:55], v[168:171]
    v_exp_f32 v74, v74
    v_mfma_f32_16x16x32_bf16 v[168:171], a[232:235], a[80:83], v[168:171]
    v_mfma_f32_16x16x32_bf16 v[168:171], a[236:239], a[108:111], v[168:171]
    s_waitcnt lgkmcnt(0)
    v_exp_f32 v75, v75
    v_mfma_f32_16x16x32_bf16 v[144:147], a[240:243], a[112:115], v[144:147]
    s_barrier
    s_add_u32 m0, s37, 20480
    s_add_u32 s45, s42, 81920
    v_mfma_f32_16x16x32_bf16 v[144:147], a[244:247], a[140:143], v[144:147]
    v_exp_f32 v76, v76
    v_mfma_f32_16x16x32_bf16 v[144:147], a[248:251], a[168:171], v[144:147]
    ds_read_b128 a[0:3], v20 offset:0
    v_cvt_pk_bf16_f32 v213, v74, v75
    v_mfma_f32_16x16x32_bf16 v[144:147], a[252:255], a[196:199], v[144:147]
    v_exp_f32 v77, v77
    v_mfma_f32_16x16x32_bf16 v[148:151], a[240:243], a[116:119], v[148:151]
    buffer_load_dwordx4 v12, s[12:15], s45 offen offset:0 nt lds
    v_mfma_f32_16x16x32_bf16 v[148:151], a[244:247], a[144:147], v[148:151]
    v_exp_f32 v78, v78
    v_mfma_f32_16x16x32_bf16 v[148:151], a[248:251], a[172:175], v[148:151]
    ds_read_b128 a[4:7], v20 offset:1024
    v_cvt_pk_bf16_f32 v216, v76, v77
    v_mfma_f32_16x16x32_bf16 v[148:151], a[252:255], a[200:203], v[148:151]
    ds_read_b128 a[8:11], v20 offset:2048
    v_mfma_f32_16x16x32_bf16 v[152:155], a[240:243], a[120:123], v[152:155]
    v_exp_f32 v79, v79
    v_mfma_f32_16x16x32_bf16 v[152:155], a[244:247], a[148:151], v[152:155]
    ds_read_b128 a[12:15], v20 offset:3072
    v_cvt_pk_bf16_f32 v217, v78, v79
    v_mfma_f32_16x16x32_bf16 v[152:155], a[248:251], a[176:179], v[152:155]
    v_exp_f32 v80, v80
    v_mfma_f32_16x16x32_bf16 v[152:155], a[252:255], a[204:207], v[152:155]
    ds_read_b128 a[16:19], v20 offset:4096
    v_mfma_f32_16x16x32_bf16 v[156:159], a[240:243], a[124:127], v[156:159]
    ds_read_b128 a[20:23], v20 offset:5120
    ds_read_b128 a[24:27], v20 offset:6144
    v_exp_f32 v81, v81
    s_waitcnt vmcnt(18)
    v_mfma_f32_16x16x32_bf16 v[156:159], a[244:247], a[152:155], v[156:159]
    buffer_load_dwordx4 v13, s[12:15], s45 offen offset:1024 nt lds
    v_mfma_f32_16x16x32_bf16 v[156:159], a[248:251], a[180:183], v[156:159]
    v_exp_f32 v82, v82
    v_mfma_f32_16x16x32_bf16 v[156:159], a[252:255], a[208:211], v[156:159]
    ds_read_b64_tr_b16 a[224:225], v16 offset:0
    v_cvt_pk_bf16_f32 v220, v80, v81
    v_mfma_f32_16x16x32_bf16 v[160:163], a[240:243], a[128:131], v[160:163]
    v_exp_f32 v83, v83
    v_mfma_f32_16x16x32_bf16 v[160:163], a[244:247], a[156:159], v[160:163]
    ds_read_b64_tr_b16 a[226:227], v16 offset:2048
    v_cvt_pk_bf16_f32 v221, v82, v83
    v_mfma_f32_16x16x32_bf16 v[160:163], a[248:251], a[184:187], v[160:163]
    buffer_load_dwordx4 v14, s[12:15], s45 offen offset:2048 nt lds
    v_mfma_f32_16x16x32_bf16 v[160:163], a[252:255], a[212:215], v[160:163]
    v_exp_f32 v84, v84
    v_mfma_f32_16x16x32_bf16 v[164:167], a[240:243], a[132:135], v[164:167]
    ds_read_b64_tr_b16 a[228:229], v17 offset:0
    v_mfma_f32_16x16x32_bf16 v[164:167], a[244:247], a[160:163], v[164:167]
    v_exp_f32 v85, v85
    v_mfma_f32_16x16x32_bf16 v[164:167], a[248:251], a[188:191], v[164:167]
    ds_read_b64_tr_b16 a[230:231], v17 offset:2048
    ds_read_b64_tr_b16 a[232:233], v18 offset:0
    ds_read_b64_tr_b16 a[234:235], v18 offset:2048
    ds_read_b64_tr_b16 a[236:237], v19 offset:0
    ds_read_b64_tr_b16 a[238:239], v19 offset:2048
    v_mfma_f32_16x16x32_bf16 v[164:167], a[252:255], a[216:219], v[164:167]
    v_exp_f32 v86, v86
    v_mfma_f32_16x16x32_bf16 v[168:171], a[240:243], a[136:139], v[168:171]
    v_cvt_pk_bf16_f32 v224, v84, v85
    v_mfma_f32_16x16x32_bf16 v[168:171], a[244:247], a[164:167], v[168:171]
    v_exp_f32 v87, v87
    v_mfma_f32_16x16x32_bf16 v[168:171], a[248:251], a[192:195], v[168:171]
    buffer_load_dwordx4 v15, s[12:15], s45 offen offset:3072 nt lds
    v_mfma_f32_16x16x32_bf16 v[168:171], a[252:255], a[220:223], v[168:171]
    s_waitcnt lgkmcnt(0)
    v_cvt_pk_bf16_f32 v225, v86, v87
    v_mfma_f32_16x16x32_bf16 v[32:35], a[224:227], a[0:3], 0
    s_add_u32 m0, s37, 0
    s_add_u32 s45, s42, 98304
    ds_read_b128 a[28:31], v20 offset:7168
    v_mfma_f32_16x16x32_bf16 v[36:39], a[228:231], a[0:3], 0
    v_exp_f32 v144, v144
    v_mfma_f32_16x16x32_bf16 v[40:43], a[232:235], a[0:3], 0
    ds_read_b128 a[32:35], v20 offset:8192
    v_mfma_f32_16x16x32_bf16 v[44:47], a[236:239], a[0:3], 0
    ds_read_b128 a[36:39], v20 offset:9216
    v_mfma_f32_16x16x32_bf16 v[48:51], a[224:227], a[4:7], 0
    buffer_load_dwordx4 v12, s[12:15], s45 offen offset:0 nt lds
    v_mfma_f32_16x16x32_bf16 v[52:55], a[228:231], a[4:7], 0
    v_exp_f32 v145, v145
    v_mfma_f32_16x16x32_bf16 v[56:59], a[232:235], a[4:7], 0
    ds_read_b128 a[40:43], v20 offset:10240
    v_cvt_pk_bf16_f32 v202, v144, v145
    v_mfma_f32_16x16x32_bf16 v[60:63], a[236:239], a[4:7], 0
    ds_read_b128 a[44:47], v20 offset:11264
    v_mfma_f32_16x16x32_bf16 v[64:67], a[224:227], a[8:11], 0
    ds_read_b128 a[48:51], v20 offset:12288
    v_mfma_f32_16x16x32_bf16 v[68:71], a[228:231], a[8:11], 0
    v_exp_f32 v146, v146
    v_mfma_f32_16x16x32_bf16 v[72:75], a[232:235], a[8:11], 0
    ds_read_b128 a[52:55], v20 offset:13312
    s_waitcnt vmcnt(18)
    v_mfma_f32_16x16x32_bf16 v[76:79], a[236:239], a[8:11], 0
    ds_read_b64_tr_b16 a[240:241], v16 offset:4096
    v_mfma_f32_16x16x32_bf16 v[80:83], a[224:227], a[12:15], 0
    buffer_load_dwordx4 v13, s[12:15], s45 offen offset:1024 nt lds
    v_mfma_f32_16x16x32_bf16 v[84:87], a[228:231], a[12:15], 0
    v_exp_f32 v147, v147
    v_mfma_f32_16x16x32_bf16 v[88:91], a[232:235], a[12:15], 0
    ds_read_b64_tr_b16 a[242:243], v16 offset:6144
    v_cvt_pk_bf16_f32 v203, v146, v147
    v_mfma_f32_16x16x32_bf16 v[92:95], a[236:239], a[12:15], 0
    ds_read_b64_tr_b16 a[244:245], v17 offset:4096
    v_mfma_f32_16x16x32_bf16 v[96:99], a[224:227], a[16:19], 0
    ds_read_b64_tr_b16 a[246:247], v17 offset:6144
    v_mfma_f32_16x16x32_bf16 v[100:103], a[228:231], a[16:19], 0
    v_exp_f32 v148, v148
    v_mfma_f32_16x16x32_bf16 v[104:107], a[232:235], a[16:19], 0
    ds_read_b64_tr_b16 a[248:249], v18 offset:4096
    v_mfma_f32_16x16x32_bf16 v[108:111], a[236:239], a[16:19], 0
    ds_read_b64_tr_b16 a[250:251], v18 offset:6144
    v_mfma_f32_16x16x32_bf16 v[112:115], a[224:227], a[20:23], 0
    ds_read_b64_tr_b16 a[252:253], v19 offset:4096
    v_mfma_f32_16x16x32_bf16 v[116:119], a[228:231], a[20:23], 0
    v_exp_f32 v149, v149
    v_mfma_f32_16x16x32_bf16 v[120:123], a[232:235], a[20:23], 0
    ds_read_b64_tr_b16 a[254:255], v19 offset:6144
    buffer_load_dwordx4 v14, s[12:15], s45 offen offset:2048 nt lds
    v_mfma_f32_16x16x32_bf16 v[124:127], a[236:239], a[20:23], 0
    v_cvt_pk_bf16_f32 v206, v148, v149
    v_mfma_f32_16x16x32_bf16 v[128:131], a[224:227], a[24:27], 0
    v_mfma_f32_16x16x32_bf16 v[132:135], a[228:231], a[24:27], 0
    v_exp_f32 v150, v150
    v_mfma_f32_16x16x32_bf16 v[136:139], a[232:235], a[24:27], 0
    buffer_load_dwordx4 v15, s[12:15], s45 offen offset:3072 nt lds
    v_mfma_f32_16x16x32_bf16 v[140:143], a[236:239], a[24:27], 0
    s_waitcnt lgkmcnt(0)
    v_mfma_f32_16x16x32_bf16 v[32:35], a[240:243], a[28:31], v[32:35]
    ds_read_b128 a[0:3], v20 offset:14336
    v_mfma_f32_16x16x32_bf16 v[36:39], a[244:247], a[28:31], v[36:39]
    s_add_u32 m0, s37, 4096
    v_exp_f32 v151, v151
    v_mfma_f32_16x16x32_bf16 v[40:43], a[248:251], a[28:31], v[40:43]
    s_add_u32 s45, s42, 114688
    ds_read_b128 a[4:7], v20 offset:15360
    v_cvt_pk_bf16_f32 v207, v150, v151
    v_mfma_f32_16x16x32_bf16 v[44:47], a[252:255], a[28:31], v[44:47]
    ds_read_b128 a[8:11], v20 offset:16384
    v_mfma_f32_16x16x32_bf16 v[48:51], a[240:243], a[32:35], v[48:51]
    ds_read_b128 a[12:15], v20 offset:17408
    v_mfma_f32_16x16x32_bf16 v[52:55], a[244:247], a[32:35], v[52:55]
    v_exp_f32 v152, v152
    v_mfma_f32_16x16x32_bf16 v[56:59], a[248:251], a[32:35], v[56:59]
    buffer_load_dwordx4 v12, s[12:15], s45 offen offset:0 nt lds
    v_mfma_f32_16x16x32_bf16 v[60:63], a[252:255], a[32:35], v[60:63]
    ds_read_b128 a[16:19], v20 offset:18432
    v_mfma_f32_16x16x32_bf16 v[64:67], a[240:243], a[36:39], v[64:67]
    ds_read_b128 a[20:23], v20 offset:19456
    v_mfma_f32_16x16x32_bf16 v[68:71], a[244:247], a[36:39], v[68:71]
    v_exp_f32 v153, v153
    v_mfma_f32_16x16x32_bf16 v[72:75], a[248:251], a[36:39], v[72:75]
    ds_read_b128 a[24:27], v20 offset:20480
    s_waitcnt vmcnt(17)
    v_mfma_f32_16x16x32_bf16 v[76:79], a[252:255], a[36:39], v[76:79]
    ds_read_b64_tr_b16 a[224:225], v16 offset:8192
    v_cvt_pk_bf16_f32 v210, v152, v153
    v_mfma_f32_16x16x32_bf16 v[80:83], a[240:243], a[40:43], v[80:83]
    buffer_load_dwordx4 v13, s[12:15], s45 offen offset:1024 nt lds
    v_mfma_f32_16x16x32_bf16 v[84:87], a[244:247], a[40:43], v[84:87]
    v_exp_f32 v154, v154
    v_mfma_f32_16x16x32_bf16 v[88:91], a[248:251], a[40:43], v[88:91]
    ds_read_b64_tr_b16 a[226:227], v16 offset:10240
    v_mfma_f32_16x16x32_bf16 v[92:95], a[252:255], a[40:43], v[92:95]
    ds_read_b64_tr_b16 a[228:229], v17 offset:8192
    v_mfma_f32_16x16x32_bf16 v[96:99], a[240:243], a[44:47], v[96:99]
    ds_read_b64_tr_b16 a[230:231], v17 offset:10240
    v_mfma_f32_16x16x32_bf16 v[100:103], a[244:247], a[44:47], v[100:103]
    v_exp_f32 v155, v155
    v_mfma_f32_16x16x32_bf16 v[104:107], a[248:251], a[44:47], v[104:107]
    ds_read_b64_tr_b16 a[232:233], v18 offset:8192
    v_cvt_pk_bf16_f32 v211, v154, v155
    v_mfma_f32_16x16x32_bf16 v[108:111], a[252:255], a[44:47], v[108:111]
    ds_read_b64_tr_b16 a[234:235], v18 offset:10240
    v_mfma_f32_16x16x32_bf16 v[112:115], a[240:243], a[48:51], v[112:115]
    ds_read_b64_tr_b16 a[236:237], v19 offset:8192
    v_mfma_f32_16x16x32_bf16 v[116:119], a[244:247], a[48:51], v[116:119]
    v_exp_f32 v156, v156
    v_mfma_f32_16x16x32_bf16 v[120:123], a[248:251], a[48:51], v[120:123]
    ds_read_b64_tr_b16 a[238:239], v19 offset:10240
    v_mfma_f32_16x16x32_bf16 v[124:127], a[252:255], a[48:51], v[124:127]
    buffer_load_dwordx4 v14, s[12:15], s45 offen offset:2048 nt lds
    v_mfma_f32_16x16x32_bf16 v[128:131], a[240:243], a[52:55], v[128:131]
    v_mfma_f32_16x16x32_bf16 v[132:135], a[244:247], a[52:55], v[132:135]
    v_exp_f32 v157, v157
    v_mfma_f32_16x16x32_bf16 v[136:139], a[248:251], a[52:55], v[136:139]
    v_cvt_pk_bf16_f32 v214, v156, v157
    v_mfma_f32_16x16x32_bf16 v[140:143], a[252:255], a[52:55], v[140:143]
    s_waitcnt lgkmcnt(0)
    v_mfma_f32_16x16x32_bf16 v[32:35], a[224:227], a[0:3], v[32:35]
    buffer_load_dwordx4 v15, s[12:15], s45 offen offset:3072 nt lds
    v_mfma_f32_16x16x32_bf16 v[36:39], a[228:231], a[0:3], v[36:39]
    v_exp_f32 v158, v158
    v_mfma_f32_16x16x32_bf16 v[40:43], a[232:235], a[0:3], v[40:43]
    s_add_u32 m0, s37, 8192
    s_add_u32 s45, s42, 131072
    ds_read_b128 a[28:31], v20 offset:21504
    v_mfma_f32_16x16x32_bf16 v[44:47], a[236:239], a[0:3], v[44:47]
    ds_read_b128 a[32:35], v20 offset:22528
    v_mfma_f32_16x16x32_bf16 v[48:51], a[224:227], a[4:7], v[48:51]
    ds_read_b128 a[36:39], v20 offset:23552
    v_mfma_f32_16x16x32_bf16 v[52:55], a[228:231], a[4:7], v[52:55]
    v_exp_f32 v159, v159
    v_mfma_f32_16x16x32_bf16 v[56:59], a[232:235], a[4:7], v[56:59]
    buffer_load_dwordx4 v12, s[12:15], s45 offen offset:0 nt lds
    v_mfma_f32_16x16x32_bf16 v[60:63], a[236:239], a[4:7], v[60:63]
    ds_read_b128 a[40:43], v20 offset:24576
    v_cvt_pk_bf16_f32 v215, v158, v159
    v_mfma_f32_16x16x32_bf16 v[64:67], a[224:227], a[8:11], v[64:67]
    ds_read_b128 a[44:47], v20 offset:25600
    v_mfma_f32_16x16x32_bf16 v[68:71], a[228:231], a[8:11], v[68:71]
    v_exp_f32 v160, v160
    v_mfma_f32_16x16x32_bf16 v[72:75], a[232:235], a[8:11], v[72:75]
    ds_read_b128 a[48:51], v20 offset:26624
    v_mfma_f32_16x16x32_bf16 v[76:79], a[236:239], a[8:11], v[76:79]
    ds_read_b128 a[52:55], v20 offset:27648
    s_waitcnt vmcnt(17)
    v_mfma_f32_16x16x32_bf16 v[80:83], a[224:227], a[12:15], v[80:83]
    ds_read_b64_tr_b16 a[240:241], v16 offset:12288
    v_mfma_f32_16x16x32_bf16 v[84:87], a[228:231], a[12:15], v[84:87]
    v_exp_f32 v161, v161
    v_mfma_f32_16x16x32_bf16 v[88:91], a[232:235], a[12:15], v[88:91]
    buffer_load_dwordx4 v13, s[12:15], s45 offen offset:1024 nt lds
    v_mfma_f32_16x16x32_bf16 v[92:95], a[236:239], a[12:15], v[92:95]
    ds_read_b64_tr_b16 a[242:243], v16 offset:14336
    v_cvt_pk_bf16_f32 v218, v160, v161
    v_mfma_f32_16x16x32_bf16 v[96:99], a[224:227], a[16:19], v[96:99]
    ds_read_b64_tr_b16 a[244:245], v17 offset:12288
    v_mfma_f32_16x16x32_bf16 v[100:103], a[228:231], a[16:19], v[100:103]
    v_exp_f32 v162, v162
    v_mfma_f32_16x16x32_bf16 v[104:107], a[232:235], a[16:19], v[104:107]
    ds_read_b64_tr_b16 a[246:247], v17 offset:14336
    v_mfma_f32_16x16x32_bf16 v[108:111], a[236:239], a[16:19], v[108:111]
    ds_read_b64_tr_b16 a[248:249], v18 offset:12288
    v_mfma_f32_16x16x32_bf16 v[112:115], a[224:227], a[20:23], v[112:115]
    ds_read_b64_tr_b16 a[250:251], v18 offset:14336
    v_mfma_f32_16x16x32_bf16 v[116:119], a[228:231], a[20:23], v[116:119]
    v_exp_f32 v163, v163
    v_mfma_f32_16x16x32_bf16 v[120:123], a[232:235], a[20:23], v[120:123]
    ds_read_b64_tr_b16 a[252:253], v19 offset:12288
    ds_read_b64_tr_b16 a[254:255], v19 offset:14336
    v_mfma_f32_16x16x32_bf16 v[124:127], a[236:239], a[20:23], v[124:127]
    buffer_load_dwordx4 v14, s[12:15], s45 offen offset:2048 nt lds
    v_mfma_f32_16x16x32_bf16 v[128:131], a[224:227], a[24:27], v[128:131]
    v_cvt_pk_bf16_f32 v219, v162, v163
    v_mfma_f32_16x16x32_bf16 v[132:135], a[228:231], a[24:27], v[132:135]
    v_exp_f32 v164, v164
    v_mfma_f32_16x16x32_bf16 v[136:139], a[232:235], a[24:27], v[136:139]
    v_mfma_f32_16x16x32_bf16 v[140:143], a[236:239], a[24:27], v[140:143]
    s_waitcnt lgkmcnt(0)
    v_mfma_f32_16x16x32_bf16 v[32:35], a[240:243], a[28:31], v[32:35]
    s_barrier
    ds_read_b128 a[0:3], v20 offset:28672
    v_mfma_f32_16x16x32_bf16 v[36:39], a[244:247], a[28:31], v[36:39]
    v_exp_f32 v165, v165
    v_mfma_f32_16x16x32_bf16 v[40:43], a[248:251], a[28:31], v[40:43]
    buffer_load_dwordx4 v15, s[12:15], s45 offen offset:3072 nt lds
    v_mfma_f32_16x16x32_bf16 v[44:47], a[252:255], a[28:31], v[44:47]
    s_add_u32 m0, s37, 12288
    v_cvt_pk_bf16_f32 v222, v164, v165
    s_add_u32 s45, s42, 147456
    v_mfma_f32_16x16x32_bf16 v[48:51], a[240:243], a[32:35], v[48:51]
    ds_read_b128 a[4:7], v20 offset:29696
    v_mfma_f32_16x16x32_bf16 v[52:55], a[244:247], a[32:35], v[52:55]
    v_exp_f32 v166, v166
    v_mfma_f32_16x16x32_bf16 v[56:59], a[248:251], a[32:35], v[56:59]
    ds_read_b128 a[8:11], v20 offset:30720
    v_mfma_f32_16x16x32_bf16 v[60:63], a[252:255], a[32:35], v[60:63]
    buffer_load_dwordx4 v12, s[12:15], s45 offen offset:0 nt lds
    v_mfma_f32_16x16x32_bf16 v[64:67], a[240:243], a[36:39], v[64:67]
    ds_read_b128 a[12:15], v20 offset:31744
    v_mfma_f32_16x16x32_bf16 v[68:71], a[244:247], a[36:39], v[68:71]
    v_exp_f32 v167, v167
    v_mfma_f32_16x16x32_bf16 v[72:75], a[248:251], a[36:39], v[72:75]
    ds_read_b128 a[16:19], v20 offset:32768
    v_cvt_pk_bf16_f32 v223, v166, v167
    v_mfma_f32_16x16x32_bf16 v[76:79], a[252:255], a[36:39], v[76:79]
    ds_read_b128 a[20:23], v20 offset:33792
    v_mfma_f32_16x16x32_bf16 v[80:83], a[240:243], a[40:43], v[80:83]
    ds_read_b128 a[24:27], v20 offset:34816
    s_waitcnt vmcnt(17)
    v_mfma_f32_16x16x32_bf16 v[84:87], a[244:247], a[40:43], v[84:87]
    v_exp_f32 v168, v168
    v_mfma_f32_16x16x32_bf16 v[88:91], a[248:251], a[40:43], v[88:91]
    buffer_load_dwordx4 v13, s[12:15], s45 offen offset:1024 nt lds
    v_mfma_f32_16x16x32_bf16 v[92:95], a[252:255], a[40:43], v[92:95]
    ds_read_b64_tr_b16 a[224:225], v16 offset:16384
    v_mfma_f32_16x16x32_bf16 v[96:99], a[240:243], a[44:47], v[96:99]
    ds_read_b64_tr_b16 a[226:227], v16 offset:18432
    v_mfma_f32_16x16x32_bf16 v[100:103], a[244:247], a[44:47], v[100:103]
    v_exp_f32 v169, v169
    v_mfma_f32_16x16x32_bf16 v[104:107], a[248:251], a[44:47], v[104:107]
    ds_read_b64_tr_b16 a[228:229], v17 offset:16384
    v_cvt_pk_bf16_f32 v226, v168, v169
    v_mfma_f32_16x16x32_bf16 v[108:111], a[252:255], a[44:47], v[108:111]
    ds_read_b64_tr_b16 a[230:231], v17 offset:18432
    v_mfma_f32_16x16x32_bf16 v[112:115], a[240:243], a[48:51], v[112:115]
    ds_read_b64_tr_b16 a[232:233], v18 offset:16384
    v_mfma_f32_16x16x32_bf16 v[116:119], a[244:247], a[48:51], v[116:119]
    v_exp_f32 v170, v170
    v_mfma_f32_16x16x32_bf16 v[120:123], a[248:251], a[48:51], v[120:123]
    ds_read_b64_tr_b16 a[234:235], v18 offset:18432
    ds_read_b64_tr_b16 a[236:237], v19 offset:16384
    ds_read_b64_tr_b16 a[238:239], v19 offset:18432
    v_mfma_f32_16x16x32_bf16 v[124:127], a[252:255], a[48:51], v[124:127]
    buffer_load_dwordx4 v14, s[12:15], s45 offen offset:2048 nt lds
    v_mfma_f32_16x16x32_bf16 v[128:131], a[240:243], a[52:55], v[128:131]
    ds_write_b128 v21, v[172:175] offset:0
    v_mfma_f32_16x16x32_bf16 v[132:135], a[244:247], a[52:55], v[132:135]
    v_exp_f32 v171, v171
    v_mfma_f32_16x16x32_bf16 v[136:139], a[248:251], a[52:55], v[136:139]
    v_cvt_pk_bf16_f32 v227, v170, v171
    v_mfma_f32_16x16x32_bf16 v[140:143], a[252:255], a[52:55], v[140:143]
    s_waitcnt lgkmcnt(1)
    ds_write_b128 v21, v[176:179] offset:1024
    v_mfma_f32_16x16x32_bf16 v[32:35], a[224:227], a[0:3], v[32:35]
    buffer_load_dwordx4 v15, s[12:15], s45 offen offset:3072 nt lds
    v_mfma_f32_16x16x32_bf16 v[36:39], a[228:231], a[0:3], v[36:39]
    v_mfma_f32_16x16x32_bf16 v[40:43], a[232:235], a[0:3], v[40:43]
    ds_write_b128 v21, v[180:183] offset:2048
    v_mfma_f32_16x16x32_bf16 v[44:47], a[236:239], a[0:3], v[44:47]
    v_mfma_f32_16x16x32_bf16 v[48:51], a[224:227], a[4:7], v[48:51]
    s_add_u32 m0, s37, 16384
    s_add_u32 s45, s42, 163840
    v_mfma_f32_16x16x32_bf16 v[52:55], a[228:231], a[4:7], v[52:55]
    ds_read_b128 a[28:31], v20 offset:35840
    v_mfma_f32_16x16x32_bf16 v[56:59], a[232:235], a[4:7], v[56:59]
    ds_read_b128 a[32:35], v20 offset:36864
    v_mfma_f32_16x16x32_bf16 v[60:63], a[236:239], a[4:7], v[60:63]
    ds_read_b128 a[36:39], v20 offset:37888
    v_mfma_f32_16x16x32_bf16 v[64:67], a[224:227], a[8:11], v[64:67]
    buffer_load_dwordx4 v12, s[12:15], s45 offen offset:0 nt lds
    v_mfma_f32_16x16x32_bf16 v[68:71], a[228:231], a[8:11], v[68:71]
    ds_read_b128 a[40:43], v20 offset:38912
    v_mfma_f32_16x16x32_bf16 v[72:75], a[232:235], a[8:11], v[72:75]
    ds_read_b128 a[44:47], v20 offset:39936
    v_mfma_f32_16x16x32_bf16 v[76:79], a[236:239], a[8:11], v[76:79]
    ds_read_b128 a[48:51], v20 offset:40960
    v_mfma_f32_16x16x32_bf16 v[80:83], a[224:227], a[12:15], v[80:83]
    ds_read_b128 a[52:55], v20 offset:41984
    v_mfma_f32_16x16x32_bf16 v[84:87], a[228:231], a[12:15], v[84:87]
    v_mfma_f32_16x16x32_bf16 v[88:91], a[232:235], a[12:15], v[88:91]
    v_mfma_f32_16x16x32_bf16 v[92:95], a[236:239], a[12:15], v[92:95]
    buffer_load_dwordx4 v13, s[12:15], s45 offen offset:1024 nt lds
    v_mfma_f32_16x16x32_bf16 v[28:31], v[228:231], v[200:203], v[28:31]
    v_mfma_f32_16x16x32_bf16 v[28:31], v[232:235], v[204:207], v[28:31]
    s_waitcnt vmcnt(18)
    ds_read_b64_tr_b16 a[240:241], v16 offset:20480
    v_mfma_f32_16x16x32_bf16 v[28:31], v[236:239], v[208:211], v[28:31]
    ds_read_b64_tr_b16 a[242:243], v16 offset:22528
    v_mfma_f32_16x16x32_bf16 v[28:31], v[240:243], v[212:215], v[28:31]
    ds_read_b64_tr_b16 a[244:245], v17 offset:20480
    v_mfma_f32_16x16x32_bf16 v[28:31], v[244:247], v[216:219], v[28:31]
    ds_read_b64_tr_b16 a[246:247], v17 offset:22528
    v_mfma_f32_16x16x32_bf16 v[28:31], v[248:251], v[220:223], v[28:31]
    ds_read_b64_tr_b16 a[248:249], v18 offset:20480
    v_mfma_f32_16x16x32_bf16 v[28:31], v[252:255], v[224:227], v[28:31]
    buffer_load_dwordx4 v14, s[12:15], s45 offen offset:2048 nt lds
    v_mfma_f32_16x16x32_bf16 v[96:99], a[224:227], a[16:19], v[96:99]
    ds_read_b64_tr_b16 a[250:251], v18 offset:22528
    v_mfma_f32_16x16x32_bf16 v[100:103], a[228:231], a[16:19], v[100:103]
    ds_read_b64_tr_b16 a[252:253], v19 offset:20480
    v_mfma_f32_16x16x32_bf16 v[104:107], a[232:235], a[16:19], v[104:107]
    ds_read_b64_tr_b16 a[254:255], v19 offset:22528
    v_mfma_f32_16x16x32_bf16 v[108:111], a[236:239], a[16:19], v[108:111]
    ds_write_b128 v21, v[184:187] offset:3072
    v_mfma_f32_16x16x32_bf16 v[112:115], a[224:227], a[20:23], v[112:115]
    v_mfma_f32_16x16x32_bf16 v[116:119], a[228:231], a[20:23], v[116:119]
    v_mfma_f32_16x16x32_bf16 v[120:123], a[232:235], a[20:23], v[120:123]
    buffer_load_dwordx4 v15, s[12:15], s45 offen offset:3072 nt lds
    v_mfma_f32_16x16x32_bf16 v[124:127], a[236:239], a[20:23], v[124:127]
    ds_write_b128 v21, v[188:191] offset:4096
    v_mfma_f32_16x16x32_bf16 v[128:131], a[224:227], a[24:27], v[128:131]
    v_mfma_f32_16x16x32_bf16 v[132:135], a[228:231], a[24:27], v[132:135]
    v_mfma_f32_16x16x32_bf16 v[136:139], a[232:235], a[24:27], v[136:139]
    v_mfma_f32_16x16x32_bf16 v[140:143], a[236:239], a[24:27], v[140:143]
    s_waitcnt lgkmcnt(2)
    v_mfma_f32_16x16x32_bf16 v[32:35], a[240:243], a[28:31], v[32:35]
    s_add_u32 m0, s37, 20480
    s_add_u32 s45, s42, 180224
    ds_read_b128 a[0:3], v20 offset:43008
    v_mfma_f32_16x16x32_bf16 v[36:39], a[244:247], a[28:31], v[36:39]
    ds_read_b128 a[4:7], v20 offset:44032
    v_add_u32 v144, 0, v25
    v_mfma_f32_16x16x32_bf16 v[40:43], a[248:251], a[28:31], v[40:43]
    ds_read_b128 a[8:11], v20 offset:45056
    v_add_u32 v145, 6144, v25
    v_mfma_f32_16x16x32_bf16 v[44:47], a[252:255], a[28:31], v[44:47]
    ds_read_b128 a[12:15], v20 offset:46080
    v_add_u32 v146, 12288, v25
    v_mfma_f32_16x16x32_bf16 v[48:51], a[240:243], a[32:35], v[48:51]
    buffer_load_dwordx4 v12, s[12:15], s45 offen offset:0 nt lds
    v_mfma_f32_16x16x32_bf16 v[52:55], a[244:247], a[32:35], v[52:55]
    ds_read_b128 a[16:19], v20 offset:47104
    v_add_u32 v147, 18432, v25
    v_mfma_f32_16x16x32_bf16 v[56:59], a[248:251], a[32:35], v[56:59]
    ds_read_b128 a[20:23], v20 offset:48128
    v_mov_b32 v148, v26
    v_mfma_f32_16x16x32_bf16 v[60:63], a[252:255], a[32:35], v[60:63]
    ds_read_b128 a[24:27], v20 offset:49152
    v_add_u32 v149, 49152, v26
    v_mfma_f32_16x16x32_bf16 v[64:67], a[240:243], a[36:39], v[64:67]
    v_and_b32 v151, 31, v0
    v_lshrrev_b32 v150, 5, v0
    v_mfma_f32_16x16x32_bf16 v[68:71], a[244:247], a[36:39], v[68:71]
    v_lshlrev_b32 v150, 4, v150
    v_lshl_add_u32 v151, v151, 5, v150
    v_mfma_f32_16x16x32_bf16 v[72:75], a[248:251], a[36:39], v[72:75]
    s_waitcnt vmcnt(17)
    ds_read_b64_tr_b16 a[224:225], v16 offset:0
    v_lshrrev_b32 v150, 4, v0
    v_mfma_f32_16x16x32_bf16 v[76:79], a[252:255], a[36:39], v[76:79]
    buffer_load_dwordx4 v13, s[12:15], s45 offen offset:1024 nt lds
    v_mfma_f32_16x16x32_bf16 v[80:83], a[240:243], a[40:43], v[80:83]
    ds_read_b64_tr_b16 a[226:227], v16 offset:2048
    v_lshlrev_b32 v150, 3, v150
    v_mfma_f32_16x16x32_bf16 v[84:87], a[244:247], a[40:43], v[84:87]
    ds_read_b64_tr_b16 a[228:229], v17 offset:0
    v_and_b32 v152, 15, v0
    v_mfma_f32_16x16x32_bf16 v[88:91], a[248:251], a[40:43], v[88:91]
    ds_read_b64_tr_b16 a[230:231], v17 offset:2048
    v_lshl_add_u32 v150, v152, 5, v150
    v_mfma_f32_16x16x32_bf16 v[92:95], a[252:255], a[40:43], v[92:95]
    ds_read_b64_tr_b16 a[232:233], v18 offset:0
    v_mfma_f32_16x16x32_bf16 v[96:99], a[240:243], a[44:47], v[96:99]
    ds_read_b64_tr_b16 a[234:235], v18 offset:2048
    v_mfma_f32_16x16x32_bf16 v[100:103], a[244:247], a[44:47], v[100:103]
    ds_read_b64_tr_b16 a[236:237], v19 offset:0
    v_mfma_f32_16x16x32_bf16 v[104:107], a[248:251], a[44:47], v[104:107]
    buffer_load_dwordx4 v14, s[12:15], s45 offen offset:2048 nt lds
    v_mfma_f32_16x16x32_bf16 v[108:111], a[252:255], a[44:47], v[108:111]
    ds_read_b64_tr_b16 a[238:239], v19 offset:2048
    v_mfma_f32_16x16x32_bf16 v[112:115], a[240:243], a[48:51], v[112:115]
    ds_write_b128 v21, v[192:195] offset:5120
    v_mfma_f32_16x16x32_bf16 v[116:119], a[244:247], a[48:51], v[116:119]
    v_mfma_f32_16x16x32_bf16 v[120:123], a[248:251], a[48:51], v[120:123]
    v_mfma_f32_16x16x32_bf16 v[124:127], a[252:255], a[48:51], v[124:127]
    ds_write_b128 v21, v[196:199] offset:6144
    v_mfma_f32_16x16x32_bf16 v[128:131], a[240:243], a[52:55], v[128:131]
    v_mfma_f32_16x16x32_bf16 v[132:135], a[244:247], a[52:55], v[132:135]
    buffer_load_dwordx4 v15, s[12:15], s45 offen offset:3072 nt lds
    v_mfma_f32_16x16x32_bf16 v[136:139], a[248:251], a[52:55], v[136:139]
    v_mfma_f32_16x16x32_bf16 v[140:143], a[252:255], a[52:55], v[140:143]
    s_waitcnt lgkmcnt(2)
    v_mfma_f32_16x16x32_bf16 v[32:35], a[224:227], a[0:3], v[32:35]
    s_add_u32 m0, s37, 0
    ds_write_b128 v23, v[28:31] offset:0
    v_mfma_f32_16x16x32_bf16 v[36:39], a[228:231], a[0:3], v[36:39]
    s_add_u32 s45, s42, 196608
    v_mfma_f32_16x16x32_bf16 v[40:43], a[232:235], a[0:3], v[40:43]
    v_mfma_f32_16x16x32_bf16 v[44:47], a[236:239], a[0:3], v[44:47]
    ds_read_b128 a[28:31], v20 offset:50176
    v_mfma_f32_16x16x32_bf16 v[48:51], a[224:227], a[4:7], v[48:51]
    buffer_load_dwordx4 v12, s[12:15], s45 offen offset:0 nt lds
    v_mfma_f32_16x16x32_bf16 v[52:55], a[228:231], a[4:7], v[52:55]
    ds_read_b128 a[32:35], v20 offset:51200
    v_mfma_f32_16x16x32_bf16 v[56:59], a[232:235], a[4:7], v[56:59]
    ds_read_b128 a[36:39], v20 offset:52224
    v_mfma_f32_16x16x32_bf16 v[60:63], a[236:239], a[4:7], v[60:63]
    ds_read_b128 a[40:43], v20 offset:53248
    v_mfma_f32_16x16x32_bf16 v[64:67], a[224:227], a[8:11], v[64:67]
    ds_read_b128 a[44:47], v20 offset:54272
    v_mfma_f32_16x16x32_bf16 v[68:71], a[228:231], a[8:11], v[68:71]
    ds_read_b128 a[48:51], v20 offset:55296
    v_mfma_f32_16x16x32_bf16 v[72:75], a[232:235], a[8:11], v[72:75]
    ds_read_b128 a[52:55], v20 offset:56320
    s_waitcnt vmcnt(17)
    v_mfma_f32_16x16x32_bf16 v[76:79], a[236:239], a[8:11], v[76:79]
    ds_read_b64_tr_b16 a[240:241], v16 offset:4096
    v_mfma_f32_16x16x32_bf16 v[80:83], a[224:227], a[12:15], v[80:83]
    buffer_load_dwordx4 v13, s[12:15], s45 offen offset:1024 nt lds
    v_mfma_f32_16x16x32_bf16 v[84:87], a[228:231], a[12:15], v[84:87]
    ds_read_b64_tr_b16 a[242:243], v16 offset:6144
    v_mfma_f32_16x16x32_bf16 v[88:91], a[232:235], a[12:15], v[88:91]
    ds_read_b64_tr_b16 a[244:245], v17 offset:4096
    v_mfma_f32_16x16x32_bf16 v[92:95], a[236:239], a[12:15], v[92:95]
    ds_read_b64_tr_b16 a[246:247], v17 offset:6144
    v_mfma_f32_16x16x32_bf16 v[96:99], a[224:227], a[16:19], v[96:99]
    ds_read_b64_tr_b16 a[248:249], v18 offset:4096
    v_mfma_f32_16x16x32_bf16 v[100:103], a[228:231], a[16:19], v[100:103]
    ds_read_b64_tr_b16 a[250:251], v18 offset:6144
    v_mfma_f32_16x16x32_bf16 v[104:107], a[232:235], a[16:19], v[104:107]
    ds_read_b64_tr_b16 a[252:253], v19 offset:4096
    v_mfma_f32_16x16x32_bf16 v[108:111], a[236:239], a[16:19], v[108:111]
    ds_read_b64_tr_b16 a[254:255], v19 offset:6144
    v_mfma_f32_16x16x32_bf16 v[112:115], a[224:227], a[20:23], v[112:115]
    buffer_load_dwordx4 v14, s[12:15], s45 offen offset:2048 nt lds
    v_mfma_f32_16x16x32_bf16 v[116:119], a[228:231], a[20:23], v[116:119]
    v_mfma_f32_16x16x32_bf16 v[120:123], a[232:235], a[20:23], v[120:123]
    v_mfma_f32_16x16x32_bf16 v[124:127], a[236:239], a[20:23], v[124:127]
    v_mfma_f32_16x16x32_bf16 v[128:131], a[224:227], a[24:27], v[128:131]
    v_mfma_f32_16x16x32_bf16 v[132:135], a[228:231], a[24:27], v[132:135]
    v_mfma_f32_16x16x32_bf16 v[136:139], a[232:235], a[24:27], v[136:139]
    buffer_load_dwordx4 v15, s[12:15], s45 offen offset:3072 nt lds
    v_mfma_f32_16x16x32_bf16 v[140:143], a[236:239], a[24:27], v[140:143]
    s_waitcnt lgkmcnt(0)
    v_mfma_f32_16x16x32_bf16 v[32:35], a[240:243], a[28:31], v[32:35]
    s_barrier
    ds_read_b128 a[0:3], v20 offset:0
    v_mfma_f32_16x16x32_bf16 v[36:39], a[244:247], a[28:31], v[36:39]
    s_add_u32 m0, s37, 4096
    s_add_u32 s45, s42, 212992
    ds_read_b128 a[4:7], v20 offset:1024
    v_mfma_f32_16x16x32_bf16 v[40:43], a[248:251], a[28:31], v[40:43]
    ds_read_b128 a[8:11], v20 offset:2048
    v_mfma_f32_16x16x32_bf16 v[44:47], a[252:255], a[28:31], v[44:47]
    ds_read_b128 a[12:15], v20 offset:3072
    v_mfma_f32_16x16x32_bf16 v[48:51], a[240:243], a[32:35], v[48:51]
    ds_read_b128 a[16:19], v20 offset:4096
    v_mfma_f32_16x16x32_bf16 v[52:55], a[244:247], a[32:35], v[52:55]
    buffer_load_dwordx4 v12, s[12:15], s45 offen offset:0 nt lds
    v_mfma_f32_16x16x32_bf16 v[56:59], a[248:251], a[32:35], v[56:59]
    ds_read_b128 a[20:23], v20 offset:5120
    v_mfma_f32_16x16x32_bf16 v[60:63], a[252:255], a[32:35], v[60:63]
    ds_read_b128 a[24:27], v20 offset:6144
    v_mfma_f32_16x16x32_bf16 v[64:67], a[240:243], a[36:39], v[64:67]
    v_mfma_f32_16x16x32_bf16 v[68:71], a[244:247], a[36:39], v[68:71]
    v_mfma_f32_16x16x32_bf16 v[72:75], a[248:251], a[36:39], v[72:75]
    s_waitcnt vmcnt(17)
    ds_read_b64_tr_b16 a[224:225], v16 offset:8192
    v_mfma_f32_16x16x32_bf16 v[76:79], a[252:255], a[36:39], v[76:79]
    ds_read_b64_tr_b16 a[226:227], v16 offset:10240
    v_mfma_f32_16x16x32_bf16 v[80:83], a[240:243], a[40:43], v[80:83]
    buffer_load_dwordx4 v13, s[12:15], s45 offen offset:1024 nt lds
    v_mfma_f32_16x16x32_bf16 v[84:87], a[244:247], a[40:43], v[84:87]
    ds_read_b64_tr_b16 a[228:229], v17 offset:8192
    v_mfma_f32_16x16x32_bf16 v[88:91], a[248:251], a[40:43], v[88:91]
    ds_read_b64_tr_b16 a[230:231], v17 offset:10240
    v_mfma_f32_16x16x32_bf16 v[92:95], a[252:255], a[40:43], v[92:95]
    ds_read_b64_tr_b16 a[232:233], v18 offset:8192
    v_mfma_f32_16x16x32_bf16 v[96:99], a[240:243], a[44:47], v[96:99]
    ds_read_b64_tr_b16 a[234:235], v18 offset:10240
    v_mfma_f32_16x16x32_bf16 v[100:103], a[244:247], a[44:47], v[100:103]
    ds_read_b64_tr_b16 a[236:237], v19 offset:8192
    v_mfma_f32_16x16x32_bf16 v[104:107], a[248:251], a[44:47], v[104:107]
    ds_read_b64_tr_b16 a[238:239], v19 offset:10240
    v_mfma_f32_16x16x32_bf16 v[108:111], a[252:255], a[44:47], v[108:111]
    ds_write_b128 v21, v[200:203] offset:28672
    v_mfma_f32_16x16x32_bf16 v[112:115], a[240:243], a[48:51], v[112:115]
    buffer_load_dwordx4 v14, s[12:15], s45 offen offset:2048 nt lds
    v_mfma_f32_16x16x32_bf16 v[116:119], a[244:247], a[48:51], v[116:119]
    v_mfma_f32_16x16x32_bf16 v[120:123], a[248:251], a[48:51], v[120:123]
    ds_write_b128 v21, v[204:207] offset:29696
    v_mfma_f32_16x16x32_bf16 v[124:127], a[252:255], a[48:51], v[124:127]
    v_mfma_f32_16x16x32_bf16 v[128:131], a[240:243], a[52:55], v[128:131]
    v_mfma_f32_16x16x32_bf16 v[132:135], a[244:247], a[52:55], v[132:135]
    ds_write_b128 v21, v[208:211] offset:30720
    v_mfma_f32_16x16x32_bf16 v[136:139], a[248:251], a[52:55], v[136:139]
    v_mfma_f32_16x16x32_bf16 v[140:143], a[252:255], a[52:55], v[140:143]
    s_waitcnt lgkmcnt(3)
    v_mfma_f32_16x16x32_bf16 v[32:35], a[224:227], a[0:3], v[32:35]
    buffer_load_dwordx4 v15, s[12:15], s45 offen offset:3072 nt lds
    v_mfma_f32_16x16x32_bf16 v[36:39], a[228:231], a[0:3], v[36:39]
    ds_read_b128 a[28:31], v20 offset:7168
    v_mfma_f32_16x16x32_bf16 v[40:43], a[232:235], a[0:3], v[40:43]
    s_add_u32 m0, s37, 8192
    s_add_u32 s45, s42, 229376
    ds_read_b128 a[32:35], v20 offset:8192
    v_mfma_f32_16x16x32_bf16 v[44:47], a[236:239], a[0:3], v[44:47]
    ds_read_b128 a[36:39], v20 offset:9216
    v_mfma_f32_16x16x32_bf16 v[48:51], a[224:227], a[4:7], v[48:51]
    ds_read_b128 a[40:43], v20 offset:10240
    v_mfma_f32_16x16x32_bf16 v[52:55], a[228:231], a[4:7], v[52:55]
    ds_read_b128 a[44:47], v20 offset:11264
    v_mfma_f32_16x16x32_bf16 v[56:59], a[232:235], a[4:7], v[56:59]
    buffer_load_dwordx4 v12, s[12:15], s45 offen offset:0 nt lds
    v_mfma_f32_16x16x32_bf16 v[60:63], a[236:239], a[4:7], v[60:63]
    ds_read_b128 a[48:51], v20 offset:12288
    v_mfma_f32_16x16x32_bf16 v[64:67], a[224:227], a[8:11], v[64:67]
    ds_read_b128 a[52:55], v20 offset:13312
    v_mfma_f32_16x16x32_bf16 v[68:71], a[228:231], a[8:11], v[68:71]
    v_mfma_f32_16x16x32_bf16 v[72:75], a[232:235], a[8:11], v[72:75]
    s_waitcnt vmcnt(17)
    ds_read_b64_tr_b16 a[240:241], v16 offset:12288
    v_mfma_f32_16x16x32_bf16 v[76:79], a[236:239], a[8:11], v[76:79]
    ds_read_b64_tr_b16 a[242:243], v16 offset:14336
    v_mfma_f32_16x16x32_bf16 v[80:83], a[224:227], a[12:15], v[80:83]
    ds_read_b64_tr_b16 a[244:245], v17 offset:12288
    v_mfma_f32_16x16x32_bf16 v[84:87], a[228:231], a[12:15], v[84:87]
    buffer_load_dwordx4 v13, s[12:15], s45 offen offset:1024 nt lds
    v_mfma_f32_16x16x32_bf16 v[88:91], a[232:235], a[12:15], v[88:91]
    ds_read_b64_tr_b16 a[246:247], v17 offset:14336
    v_mfma_f32_16x16x32_bf16 v[92:95], a[236:239], a[12:15], v[92:95]
    ds_read_b64_tr_b16 a[248:249], v18 offset:12288
    v_mfma_f32_16x16x32_bf16 v[96:99], a[224:227], a[16:19], v[96:99]
    ds_read_b64_tr_b16 a[250:251], v18 offset:14336
    v_mfma_f32_16x16x32_bf16 v[100:103], a[228:231], a[16:19], v[100:103]
    ds_read_b64_tr_b16 a[252:253], v19 offset:12288
    v_mfma_f32_16x16x32_bf16 v[104:107], a[232:235], a[16:19], v[104:107]
    ds_read_b64_tr_b16 a[254:255], v19 offset:14336
    v_mfma_f32_16x16x32_bf16 v[108:111], a[236:239], a[16:19], v[108:111]
    ds_write_b128 v21, v[212:215] offset:31744
    v_mfma_f32_16x16x32_bf16 v[112:115], a[224:227], a[20:23], v[112:115]
    buffer_load_dwordx4 v14, s[12:15], s45 offen offset:2048 nt lds
    v_mfma_f32_16x16x32_bf16 v[116:119], a[228:231], a[20:23], v[116:119]
    v_mfma_f32_16x16x32_bf16 v[120:123], a[232:235], a[20:23], v[120:123]
    ds_write_b128 v21, v[216:219] offset:32768
    v_mfma_f32_16x16x32_bf16 v[124:127], a[236:239], a[20:23], v[124:127]
    v_mfma_f32_16x16x32_bf16 v[128:131], a[224:227], a[24:27], v[128:131]
    v_mfma_f32_16x16x32_bf16 v[132:135], a[228:231], a[24:27], v[132:135]
    v_mfma_f32_16x16x32_bf16 v[136:139], a[232:235], a[24:27], v[136:139]
    v_mfma_f32_16x16x32_bf16 v[140:143], a[236:239], a[24:27], v[140:143]
    s_waitcnt lgkmcnt(2)
    v_mfma_f32_16x16x32_bf16 v[32:35], a[240:243], a[28:31], v[32:35]
    buffer_load_dwordx4 v15, s[12:15], s45 offen offset:3072 nt lds
    v_mfma_f32_16x16x32_bf16 v[36:39], a[244:247], a[28:31], v[36:39]
    ds_read_b128 a[0:3], v20 offset:14336
    v_mfma_f32_16x16x32_bf16 v[40:43], a[248:251], a[28:31], v[40:43]
    ds_read_b128 a[4:7], v20 offset:15360
    v_mfma_f32_16x16x32_bf16 v[44:47], a[252:255], a[28:31], v[44:47]
    s_add_u32 m0, s37, 12288
    s_add_u32 s45, s42, 245760
    ds_read_b128 a[8:11], v20 offset:16384
    v_mfma_f32_16x16x32_bf16 v[48:51], a[240:243], a[32:35], v[48:51]
    ds_read_b128 a[12:15], v20 offset:17408
    v_mfma_f32_16x16x32_bf16 v[52:55], a[244:247], a[32:35], v[52:55]
    ds_read_b128 a[16:19], v20 offset:18432
    v_mfma_f32_16x16x32_bf16 v[56:59], a[248:251], a[32:35], v[56:59]
    ds_read_b128 a[20:23], v20 offset:19456
    v_mfma_f32_16x16x32_bf16 v[60:63], a[252:255], a[32:35], v[60:63]
    buffer_load_dwordx4 v12, s[12:15], s45 offen offset:0 nt lds
    v_mfma_f32_16x16x32_bf16 v[64:67], a[240:243], a[36:39], v[64:67]
    ds_read_b128 a[24:27], v20 offset:20480
    v_mfma_f32_16x16x32_bf16 v[68:71], a[244:247], a[36:39], v[68:71]
    v_mfma_f32_16x16x32_bf16 v[72:75], a[248:251], a[36:39], v[72:75]
    s_waitcnt vmcnt(17)
    ds_read_b64_tr_b16 a[224:225], v16 offset:16384
    v_mfma_f32_16x16x32_bf16 v[76:79], a[252:255], a[36:39], v[76:79]
    ds_read_b64_tr_b16 a[226:227], v16 offset:18432
    v_mfma_f32_16x16x32_bf16 v[80:83], a[240:243], a[40:43], v[80:83]
    ds_read_b64_tr_b16 a[228:229], v17 offset:16384
    v_mfma_f32_16x16x32_bf16 v[84:87], a[244:247], a[40:43], v[84:87]
    ds_read_b64_tr_b16 a[230:231], v17 offset:18432
    v_mfma_f32_16x16x32_bf16 v[88:91], a[248:251], a[40:43], v[88:91]
    buffer_load_dwordx4 v13, s[12:15], s45 offen offset:1024 nt lds
    v_mfma_f32_16x16x32_bf16 v[92:95], a[252:255], a[40:43], v[92:95]
    ds_read_b64_tr_b16 a[232:233], v18 offset:16384
    v_mfma_f32_16x16x32_bf16 v[96:99], a[240:243], a[44:47], v[96:99]
    ds_read_b64_tr_b16 a[234:235], v18 offset:18432
    v_mfma_f32_16x16x32_bf16 v[100:103], a[244:247], a[44:47], v[100:103]
    ds_read_b64_tr_b16 a[236:237], v19 offset:16384
    v_mfma_f32_16x16x32_bf16 v[104:107], a[248:251], a[44:47], v[104:107]
    ds_read_b64_tr_b16 a[238:239], v19 offset:18432
    v_mfma_f32_16x16x32_bf16 v[108:111], a[252:255], a[44:47], v[108:111]
    ds_write_b128 v21, v[220:223] offset:33792
    v_mfma_f32_16x16x32_bf16 v[112:115], a[240:243], a[48:51], v[112:115]
    v_mfma_f32_16x16x32_bf16 v[116:119], a[244:247], a[48:51], v[116:119]
    buffer_load_dwordx4 v14, s[12:15], s45 offen offset:2048 nt lds
    v_mfma_f32_16x16x32_bf16 v[120:123], a[248:251], a[48:51], v[120:123]
    ds_write_b128 v21, v[224:227] offset:34816
    v_mfma_f32_16x16x32_bf16 v[124:127], a[252:255], a[48:51], v[124:127]
    v_mfma_f32_16x16x32_bf16 v[128:131], a[240:243], a[52:55], v[128:131]
    v_mfma_f32_16x16x32_bf16 v[132:135], a[244:247], a[52:55], v[132:135]
    v_mfma_f32_16x16x32_bf16 v[136:139], a[248:251], a[52:55], v[136:139]
    v_mfma_f32_16x16x32_bf16 v[140:143], a[252:255], a[52:55], v[140:143]
    s_waitcnt lgkmcnt(2)
    v_mfma_f32_16x16x32_bf16 v[32:35], a[224:227], a[0:3], v[32:35]
    buffer_load_dwordx4 v15, s[12:15], s45 offen offset:3072 nt lds
    v_mfma_f32_16x16x32_bf16 v[36:39], a[228:231], a[0:3], v[36:39]
    ds_read_b128 a[28:31], v20 offset:21504
    v_mfma_f32_16x16x32_bf16 v[40:43], a[232:235], a[0:3], v[40:43]
    ds_read_b128 a[32:35], v20 offset:22528
    v_mfma_f32_16x16x32_bf16 v[44:47], a[236:239], a[0:3], v[44:47]
    ds_read_b128 a[36:39], v20 offset:23552
    v_mfma_f32_16x16x32_bf16 v[48:51], a[224:227], a[4:7], v[48:51]
    s_add_u32 m0, s37, 16384
    s_add_u32 s45, s43, s53
    ds_read_b128 a[40:43], v20 offset:24576
    v_mfma_f32_16x16x32_bf16 v[52:55], a[228:231], a[4:7], v[52:55]
    ds_read_b128 a[44:47], v20 offset:25600
    v_mfma_f32_16x16x32_bf16 v[56:59], a[232:235], a[4:7], v[56:59]
    ds_read_b128 a[48:51], v20 offset:26624
    v_mfma_f32_16x16x32_bf16 v[60:63], a[236:239], a[4:7], v[60:63]
    ds_read_b128 a[52:55], v20 offset:27648
    v_mfma_f32_16x16x32_bf16 v[64:67], a[224:227], a[8:11], v[64:67]
    buffer_load_dwordx4 v144, s[20:23], s45 offen offset:0 lds
    v_mfma_f32_16x16x32_bf16 v[68:71], a[228:231], a[8:11], v[68:71]
    v_mfma_f32_16x16x32_bf16 v[72:75], a[232:235], a[8:11], v[72:75]
    s_waitcnt vmcnt(17)
    ds_read_b64_tr_b16 a[240:241], v16 offset:20480
    v_mfma_f32_16x16x32_bf16 v[76:79], a[236:239], a[8:11], v[76:79]
    ds_read_b64_tr_b16 a[242:243], v16 offset:22528
    v_mfma_f32_16x16x32_bf16 v[80:83], a[224:227], a[12:15], v[80:83]
    ds_read_b64_tr_b16 a[244:245], v17 offset:20480
    v_mfma_f32_16x16x32_bf16 v[84:87], a[228:231], a[12:15], v[84:87]
    buffer_load_dwordx4 v145, s[20:23], s45 offen offset:1024 lds
    v_mfma_f32_16x16x32_bf16 v[88:91], a[232:235], a[12:15], v[88:91]
    ds_read_b64_tr_b16 a[246:247], v17 offset:22528
    v_mfma_f32_16x16x32_bf16 v[92:95], a[236:239], a[12:15], v[92:95]
    ds_read_b64_tr_b16 a[248:249], v18 offset:20480
    v_mfma_f32_16x16x32_bf16 v[96:99], a[224:227], a[16:19], v[96:99]
    ds_read_b64_tr_b16 a[250:251], v18 offset:22528
    v_mfma_f32_16x16x32_bf16 v[100:103], a[228:231], a[16:19], v[100:103]
    ds_read_b64_tr_b16 a[252:253], v19 offset:20480
    v_mfma_f32_16x16x32_bf16 v[104:107], a[232:235], a[16:19], v[104:107]
    buffer_load_dwordx4 v146, s[20:23], s45 offen offset:2048 lds
    v_mfma_f32_16x16x32_bf16 v[108:111], a[236:239], a[16:19], v[108:111]
    ds_read_b64_tr_b16 a[254:255], v19 offset:22528
    v_mfma_f32_16x16x32_bf16 v[112:115], a[224:227], a[20:23], v[112:115]
    v_mfma_f32_16x16x32_bf16 v[116:119], a[228:231], a[20:23], v[116:119]
    v_mfma_f32_16x16x32_bf16 v[120:123], a[232:235], a[20:23], v[120:123]
    v_mfma_f32_16x16x32_bf16 v[124:127], a[236:239], a[20:23], v[124:127]
    buffer_load_dwordx4 v147, s[20:23], s45 offen offset:3072 lds
    v_mfma_f32_16x16x32_bf16 v[128:131], a[224:227], a[24:27], v[128:131]
    v_mfma_f32_16x16x32_bf16 v[132:135], a[228:231], a[24:27], v[132:135]
    v_mfma_f32_16x16x32_bf16 v[136:139], a[232:235], a[24:27], v[136:139]
    v_mfma_f32_16x16x32_bf16 v[140:143], a[236:239], a[24:27], v[140:143]
    s_waitcnt lgkmcnt(0)
    v_mfma_f32_16x16x32_bf16 v[32:35], a[240:243], a[28:31], v[32:35]
    s_barrier
    s_add_u32 m0, s37, 20480
    s_add_u32 s45, s45, 28672
    v_mfma_f32_16x16x32_bf16 v[36:39], a[244:247], a[28:31], v[36:39]
    ds_read_b128 a[0:3], v20 offset:28672
    v_mfma_f32_16x16x32_bf16 v[40:43], a[248:251], a[28:31], v[40:43]
    ds_read_b128 a[4:7], v20 offset:29696
    v_mfma_f32_16x16x32_bf16 v[44:47], a[252:255], a[28:31], v[44:47]
    ds_read_b128 a[8:11], v20 offset:30720
    v_mfma_f32_16x16x32_bf16 v[48:51], a[240:243], a[32:35], v[48:51]
    buffer_load_dwordx4 v144, s[20:23], s45 offen offset:0 lds
    v_mfma_f32_16x16x32_bf16 v[52:55], a[244:247], a[32:35], v[52:55]
    ds_read_b128 a[12:15], v20 offset:31744
    v_mfma_f32_16x16x32_bf16 v[56:59], a[248:251], a[32:35], v[56:59]
    ds_read_b128 a[16:19], v20 offset:32768
    v_mfma_f32_16x16x32_bf16 v[60:63], a[252:255], a[32:35], v[60:63]
    ds_read_b128 a[20:23], v20 offset:33792
    v_mfma_f32_16x16x32_bf16 v[64:67], a[240:243], a[36:39], v[64:67]
    ds_read_b128 a[24:27], v20 offset:34816
    v_mfma_f32_16x16x32_bf16 v[68:71], a[244:247], a[36:39], v[68:71]
    buffer_load_dwordx4 v145, s[20:23], s45 offen offset:1024 lds
    v_mfma_f32_16x16x32_bf16 v[72:75], a[248:251], a[36:39], v[72:75]
    s_waitcnt vmcnt(18)
    ds_read_b64_tr_b16 a[224:225], v16 offset:0
    v_mfma_f32_16x16x32_bf16 v[76:79], a[252:255], a[36:39], v[76:79]
    ds_read_b64_tr_b16 a[226:227], v16 offset:2048
    v_mfma_f32_16x16x32_bf16 v[80:83], a[240:243], a[40:43], v[80:83]
    ds_read_b64_tr_b16 a[228:229], v17 offset:0
    v_mfma_f32_16x16x32_bf16 v[84:87], a[244:247], a[40:43], v[84:87]
    ds_read_b64_tr_b16 a[230:231], v17 offset:2048
    v_mfma_f32_16x16x32_bf16 v[88:91], a[248:251], a[40:43], v[88:91]
    buffer_load_dwordx4 v146, s[20:23], s45 offen offset:2048 lds
    v_mfma_f32_16x16x32_bf16 v[92:95], a[252:255], a[40:43], v[92:95]
    ds_read_b64_tr_b16 a[232:233], v18 offset:0
    v_mfma_f32_16x16x32_bf16 v[96:99], a[240:243], a[44:47], v[96:99]
    ds_read_b64_tr_b16 a[234:235], v18 offset:2048
    v_mfma_f32_16x16x32_bf16 v[100:103], a[244:247], a[44:47], v[100:103]
    ds_read_b64_tr_b16 a[236:237], v19 offset:0
    v_mfma_f32_16x16x32_bf16 v[104:107], a[248:251], a[44:47], v[104:107]
    ds_read_b64_tr_b16 a[238:239], v19 offset:2048
    v_mfma_f32_16x16x32_bf16 v[108:111], a[252:255], a[44:47], v[108:111]
    buffer_load_dwordx4 v147, s[20:23], s45 offen offset:3072 lds
    v_mfma_f32_16x16x32_bf16 v[112:115], a[240:243], a[48:51], v[112:115]
    ds_read_b128 v[228:231], v24 offset:0
    v_mfma_f32_16x16x32_bf16 v[116:119], a[244:247], a[48:51], v[116:119]
    ds_read_b128 v[232:235], v24 offset:256
    v_mfma_f32_16x16x32_bf16 v[120:123], a[248:251], a[48:51], v[120:123]
    ds_read_b128 v[236:239], v24 offset:1024
    ds_read_b128 v[240:243], v24 offset:1280
    ds_read_b128 v[244:247], v24 offset:2048
    ds_read_b128 v[248:251], v24 offset:2304
    ds_read_b128 v[252:255], v24 offset:3072
    ds_read_b128 v[172:175], v24 offset:3328
    v_mfma_f32_16x16x32_bf16 v[124:127], a[252:255], a[48:51], v[124:127]
    v_mfma_f32_16x16x32_bf16 v[128:131], a[240:243], a[52:55], v[128:131]
    v_mfma_f32_16x16x32_bf16 v[132:135], a[244:247], a[52:55], v[132:135]
    v_mfma_f32_16x16x32_bf16 v[136:139], a[248:251], a[52:55], v[136:139]
    v_mfma_f32_16x16x32_bf16 v[140:143], a[252:255], a[52:55], v[140:143]
    s_waitcnt lgkmcnt(8)
    v_mfma_f32_16x16x32_bf16 v[32:35], a[224:227], a[0:3], v[32:35]
    s_add_u32 m0, s37, 0
    s_add_u32 s45, s43, s54
    ds_read_b128 a[28:31], v20 offset:35840
    v_mfma_f32_16x16x32_bf16 v[36:39], a[228:231], a[0:3], v[36:39]
    ds_read_b128 a[32:35], v20 offset:36864
    s_waitcnt lgkmcnt(5)
    v_add_f32 v228, v228, v236
    v_mfma_f32_16x16x32_bf16 v[40:43], a[232:235], a[0:3], v[40:43]
    ds_read_b128 a[36:39], v20 offset:37888
    s_waitcnt lgkmcnt(3)
    v_add_f32 v244, v244, v252
    v_mfma_f32_16x16x32_bf16 v[44:47], a[236:239], a[0:3], v[44:47]
    ds_read_b128 a[40:43], v20 offset:38912
    v_add_f32 v228, v228, v244
    v_mfma_f32_16x16x32_bf16 v[48:51], a[224:227], a[4:7], v[48:51]
    buffer_load_dwordx4 v144, s[20:23], s45 offen offset:0 lds
    v_mfma_f32_16x16x32_bf16 v[52:55], a[228:231], a[4:7], v[52:55]
    ds_read_b128 a[44:47], v20 offset:39936
    v_mfma_f32_16x16x32_bf16 v[56:59], a[232:235], a[4:7], v[56:59]
    ds_read_b128 a[48:51], v20 offset:40960
    v_mfma_f32_16x16x32_bf16 v[60:63], a[236:239], a[4:7], v[60:63]
    ds_read_b128 a[52:55], v20 offset:41984
    v_mfma_f32_16x16x32_bf16 v[64:67], a[224:227], a[8:11], v[64:67]
    v_rcp_f32 v4, v228
    v_mfma_f32_16x16x32_bf16 v[68:71], a[228:231], a[8:11], v[68:71]
    buffer_load_dwordx4 v145, s[20:23], s45 offen offset:1024 lds
    v_mfma_f32_16x16x32_bf16 v[72:75], a[232:235], a[8:11], v[72:75]
    s_waitcnt vmcnt(18)
    ds_read_b64_tr_b16 a[240:241], v16 offset:4096
    v_add_f32 v229, v229, v237
    v_mfma_f32_16x16x32_bf16 v[76:79], a[236:239], a[8:11], v[76:79]
    ds_read_b64_tr_b16 a[242:243], v16 offset:6144
    v_add_f32 v245, v245, v253
    v_mfma_f32_16x16x32_bf16 v[80:83], a[224:227], a[12:15], v[80:83]
    ds_read_b64_tr_b16 a[244:245], v17 offset:4096
    v_add_f32 v229, v229, v245
    v_mfma_f32_16x16x32_bf16 v[84:87], a[228:231], a[12:15], v[84:87]
    ds_read_b64_tr_b16 a[246:247], v17 offset:6144
    v_mfma_f32_16x16x32_bf16 v[88:91], a[232:235], a[12:15], v[88:91]
    buffer_load_dwordx4 v146, s[20:23], s45 offen offset:2048 lds
    v_mfma_f32_16x16x32_bf16 v[92:95], a[236:239], a[12:15], v[92:95]
    ds_read_b64_tr_b16 a[248:249], v18 offset:4096
    v_mfma_f32_16x16x32_bf16 v[96:99], a[224:227], a[16:19], v[96:99]
    ds_read_b64_tr_b16 a[250:251], v18 offset:6144
    v_mfma_f32_16x16x32_bf16 v[100:103], a[228:231], a[16:19], v[100:103]
    ds_read_b64_tr_b16 a[252:253], v19 offset:4096
    v_mfma_f32_16x16x32_bf16 v[104:107], a[232:235], a[16:19], v[104:107]
    ds_read_b64_tr_b16 a[254:255], v19 offset:6144
    v_mfma_f32_16x16x32_bf16 v[108:111], a[236:239], a[16:19], v[108:111]
    buffer_load_dwordx4 v147, s[20:23], s45 offen offset:3072 lds
    v_mfma_f32_16x16x32_bf16 v[112:115], a[224:227], a[20:23], v[112:115]
    v_rcp_f32 v5, v229
    v_mfma_f32_16x16x32_bf16 v[116:119], a[228:231], a[20:23], v[116:119]
    v_add_f32 v230, v230, v238
    v_add_f32 v246, v246, v254
    v_mfma_f32_16x16x32_bf16 v[120:123], a[232:235], a[20:23], v[120:123]
    v_add_f32 v230, v230, v246
    v_mfma_f32_16x16x32_bf16 v[124:127], a[236:239], a[20:23], v[124:127]
    v_rcp_f32 v6, v230
    v_mfma_f32_16x16x32_bf16 v[128:131], a[224:227], a[24:27], v[128:131]
    v_add_f32 v231, v231, v239
    v_add_f32 v247, v247, v255
    v_mfma_f32_16x16x32_bf16 v[132:135], a[228:231], a[24:27], v[132:135]
    v_add_f32 v231, v231, v247
    v_mfma_f32_16x16x32_bf16 v[136:139], a[232:235], a[24:27], v[136:139]
    v_rcp_f32 v7, v231
    v_mfma_f32_16x16x32_bf16 v[140:143], a[236:239], a[24:27], v[140:143]
    s_waitcnt lgkmcnt(0)
    v_add_f32 v232, v232, v240
    v_add_f32 v248, v248, v172
    v_mfma_f32_16x16x32_bf16 v[32:35], a[240:243], a[28:31], v[32:35]
    s_add_u32 m0, s37, 4096
    s_add_u32 s45, s45, 28672
    ds_read_b128 a[0:3], v20 offset:43008
    v_mfma_f32_16x16x32_bf16 v[36:39], a[244:247], a[28:31], v[36:39]
    ds_read_b128 a[4:7], v20 offset:44032
    v_add_f32 v232, v232, v248
    v_mfma_f32_16x16x32_bf16 v[40:43], a[248:251], a[28:31], v[40:43]
    ds_read_b128 a[8:11], v20 offset:45056
    v_mfma_f32_16x16x32_bf16 v[44:47], a[252:255], a[28:31], v[44:47]
    ds_read_b128 a[12:15], v20 offset:46080
    v_mfma_f32_16x16x32_bf16 v[48:51], a[240:243], a[32:35], v[48:51]
    buffer_load_dwordx4 v144, s[20:23], s45 offen offset:0 lds
    v_mfma_f32_16x16x32_bf16 v[52:55], a[244:247], a[32:35], v[52:55]
    ds_read_b128 a[16:19], v20 offset:47104
    v_mfma_f32_16x16x32_bf16 v[56:59], a[248:251], a[32:35], v[56:59]
    ds_read_b128 a[20:23], v20 offset:48128
    v_mfma_f32_16x16x32_bf16 v[60:63], a[252:255], a[32:35], v[60:63]
    ds_read_b128 a[24:27], v20 offset:49152
    v_mfma_f32_16x16x32_bf16 v[64:67], a[240:243], a[36:39], v[64:67]
    v_rcp_f32 v8, v232
    v_mfma_f32_16x16x32_bf16 v[68:71], a[244:247], a[36:39], v[68:71]
    buffer_load_dwordx4 v145, s[20:23], s45 offen offset:1024 lds
    v_mfma_f32_16x16x32_bf16 v[72:75], a[248:251], a[36:39], v[72:75]
    s_waitcnt vmcnt(18)
    ds_read_b64_tr_b16 a[224:225], v16 offset:8192
    v_add_f32 v233, v233, v241
    v_mfma_f32_16x16x32_bf16 v[76:79], a[252:255], a[36:39], v[76:79]
    ds_read_b64_tr_b16 a[226:227], v16 offset:10240
    v_add_f32 v249, v249, v173
    v_mfma_f32_16x16x32_bf16 v[80:83], a[240:243], a[40:43], v[80:83]
    ds_read_b64_tr_b16 a[228:229], v17 offset:8192
    v_add_f32 v233, v233, v249
    v_mfma_f32_16x16x32_bf16 v[84:87], a[244:247], a[40:43], v[84:87]
    ds_read_b64_tr_b16 a[230:231], v17 offset:10240
    v_mfma_f32_16x16x32_bf16 v[88:91], a[248:251], a[40:43], v[88:91]
    buffer_load_dwordx4 v146, s[20:23], s45 offen offset:2048 lds
    v_mfma_f32_16x16x32_bf16 v[92:95], a[252:255], a[40:43], v[92:95]
    ds_read_b64_tr_b16 a[232:233], v18 offset:8192
    v_mfma_f32_16x16x32_bf16 v[96:99], a[240:243], a[44:47], v[96:99]
    ds_read_b64_tr_b16 a[234:235], v18 offset:10240
    v_mfma_f32_16x16x32_bf16 v[100:103], a[244:247], a[44:47], v[100:103]
    ds_read_b64_tr_b16 a[236:237], v19 offset:8192
    v_mfma_f32_16x16x32_bf16 v[104:107], a[248:251], a[44:47], v[104:107]
    ds_read_b64_tr_b16 a[238:239], v19 offset:10240
    v_mfma_f32_16x16x32_bf16 v[108:111], a[252:255], a[44:47], v[108:111]
    buffer_load_dwordx4 v147, s[20:23], s45 offen offset:3072 lds
    v_mfma_f32_16x16x32_bf16 v[112:115], a[240:243], a[48:51], v[112:115]
    v_rcp_f32 v9, v233
    v_mfma_f32_16x16x32_bf16 v[116:119], a[244:247], a[48:51], v[116:119]
    v_add_f32 v234, v234, v242
    v_add_f32 v250, v250, v174
    v_mfma_f32_16x16x32_bf16 v[120:123], a[248:251], a[48:51], v[120:123]
    v_add_f32 v234, v234, v250
    v_mfma_f32_16x16x32_bf16 v[124:127], a[252:255], a[48:51], v[124:127]
    v_rcp_f32 v10, v234
    v_mfma_f32_16x16x32_bf16 v[128:131], a[240:243], a[52:55], v[128:131]
    v_min3_f32 v238, v228, v229, v230
    v_min3_f32 v238, v238, v231, v232
    v_min3_f32 v238, v238, v233, v234
    v_add_f32 v239, v228, v229
    v_add_f32 v239, v239, v230
    v_add_f32 v239, v239, v231
    v_add_f32 v239, v239, v232
    v_add_f32 v239, v239, v233
    v_add_f32 v239, v239, v234
    v_cmp_nge_f32 vcc, 0x53800000, v239
    s_mov_b64 s[62:63], vcc
    v_cmp_nle_f32 vcc, 0x2b800000, v238
    s_or_b64 s[62:63], s[62:63], vcc
    s_cbranch_scc1 L_unsafe
L_safe:
    v_mfma_f32_16x16x32_bf16 v[132:135], a[244:247], a[52:55], v[132:135]
    v_mfma_f32_16x16x32_bf16 v[136:139], a[248:251], a[52:55], v[136:139]
    v_mfma_f32_16x16x32_bf16 v[140:143], a[252:255], a[52:55], v[140:143]
    s_waitcnt lgkmcnt(0)
    v_mfma_f32_16x16x32_bf16 v[32:35], a[224:227], a[0:3], v[32:35]
    s_add_u32 m0, s37, 8192
    s_add_u32 s45, s43, s55
    ds_read_b128 a[28:31], v20 offset:50176
    v_mfma_f32_16x16x32_bf16 v[36:39], a[228:231], a[0:3], v[36:39]
    ds_read_b128 a[32:35], v20 offset:51200
    v_mfma_f32_16x16x32_bf16 v[40:43], a[232:235], a[0:3], v[40:43]
    ds_read_b128 a[36:39], v20 offset:52224
    v_mfma_f32_16x16x32_bf16 v[44:47], a[236:239], a[0:3], v[44:47]
    ds_read_b128 a[40:43], v20 offset:53248
    v_mfma_f32_16x16x32_bf16 v[48:51], a[224:227], a[4:7], v[48:51]
    buffer_load_dwordx4 v144, s[20:23], s45 offen offset:0 lds
    v_mfma_f32_16x16x32_bf16 v[52:55], a[228:231], a[4:7], v[52:55]
    ds_read_b128 a[44:47], v20 offset:54272
    v_mfma_f32_16x16x32_bf16 v[56:59], a[232:235], a[4:7], v[56:59]
    ds_read_b128 a[48:51], v20 offset:55296
    v_mfma_f32_16x16x32_bf16 v[60:63], a[236:239], a[4:7], v[60:63]
    ds_read_b128 a[52:55], v20 offset:56320
    v_mfma_f32_16x16x32_bf16 v[64:67], a[224:227], a[8:11], v[64:67]
    v_mfma_f32_16x16x32_bf16 v[68:71], a[228:231], a[8:11], v[68:71]
    buffer_load_dwordx4 v145, s[20:23], s45 offen offset:1024 lds
    v_mfma_f32_16x16x32_bf16 v[72:75], a[232:235], a[8:11], v[72:75]
    s_waitcnt vmcnt(18)
    ds_read_b64_tr_b16 a[240:241], v16 offset:12288
    v_mfma_f32_16x16x32_bf16 v[76:79], a[236:239], a[8:11], v[76:79]
    ds_read_b64_tr_b16 a[242:243], v16 offset:14336
    v_mfma_f32_16x16x32_bf16 v[80:83], a[224:227], a[12:15], v[80:83]
    ds_read_b64_tr_b16 a[244:245], v17 offset:12288
    v_mfma_f32_16x16x32_bf16 v[84:87], a[228:231], a[12:15], v[84:87]
    ds_read_b64_tr_b16 a[246:247], v17 offset:14336
    v_mfma_f32_16x16x32_bf16 v[88:91], a[232:235], a[12:15], v[88:91]
    buffer_load_dwordx4 v146, s[20:23], s45 offen offset:2048 lds
    v_mfma_f32_16x16x32_bf16 v[92:95], a[236:239], a[12:15], v[92:95]
    ds_read_b64_tr_b16 a[248:249], v18 offset:12288
    v_mfma_f32_16x16x32_bf16 v[96:99], a[224:227], a[16:19], v[96:99]
    ds_read_b64_tr_b16 a[250:251], v18 offset:14336
    v_mfma_f32_16x16x32_bf16 v[100:103], a[228:231], a[16:19], v[100:103]
    ds_read_b64_tr_b16 a[252:253], v19 offset:12288
    v_mfma_f32_16x16x32_bf16 v[104:107], a[232:235], a[16:19], v[104:107]
    ds_read_b64_tr_b16 a[254:255], v19 offset:14336
    v_mfma_f32_16x16x32_bf16 v[108:111], a[236:239], a[16:19], v[108:111]
    buffer_load_dwordx4 v147, s[20:23], s45 offen offset:3072 lds
    v_mfma_f32_16x16x32_bf16 v[112:115], a[224:227], a[20:23], v[112:115]
    v_mfma_f32_16x16x32_bf16 v[116:119], a[228:231], a[20:23], v[116:119]
    v_mfma_f32_16x16x32_bf16 v[120:123], a[232:235], a[20:23], v[120:123]
    v_mfma_f32_16x16x32_bf16 v[124:127], a[236:239], a[20:23], v[124:127]
    v_mfma_f32_16x16x32_bf16 v[128:131], a[224:227], a[24:27], v[128:131]
    v_mfma_f32_16x16x32_bf16 v[132:135], a[228:231], a[24:27], v[132:135]
    v_mfma_f32_16x16x32_bf16 v[136:139], a[232:235], a[24:27], v[136:139]
    v_mfma_f32_16x16x32_bf16 v[140:143], a[236:239], a[24:27], v[140:143]
    s_waitcnt lgkmcnt(0)
    v_mfma_f32_16x16x32_bf16 v[32:35], a[240:243], a[28:31], v[32:35]
    s_waitcnt vmcnt(12)
    s_barrier
    s_add_u32 m0, s37, 12288
    v_mfma_f32_16x16x32_bf16 v[36:39], a[244:247], a[28:31], v[36:39]
    s_add_u32 s45, s45, 28672
    ds_read_b64_tr_b16 a[224:225], v148 offset:16384
    v_mfma_f32_16x16x32_bf16 v[40:43], a[248:251], a[28:31], v[40:43]
    ds_read_b64_tr_b16 a[226:227], v148 offset:18432
    v_mfma_f32_16x16x32_bf16 v[44:47], a[252:255], a[28:31], v[44:47]
    ds_read_b64_tr_b16 a[228:229], v148 offset:20480
    v_mfma_f32_16x16x32_bf16 v[48:51], a[240:243], a[32:35], v[48:51]
    buffer_load_dwordx4 v144, s[20:23], s45 offen offset:0 lds
    v_mfma_f32_16x16x32_bf16 v[52:55], a[244:247], a[32:35], v[52:55]
    ds_read_b64_tr_b16 a[230:231], v148 offset:22528
    v_mfma_f32_16x16x32_bf16 v[56:59], a[248:251], a[32:35], v[56:59]
    ds_read_b64_tr_b16 a[232:233], v148 offset:40960
    v_cvt_pk_bf16_f32 v32, v32, v33
    v_mfma_f32_16x16x32_bf16 v[60:63], a[252:255], a[32:35], v[60:63]
    ds_read_b64_tr_b16 a[234:235], v148 offset:43008
    v_cvt_pk_bf16_f32 v33, v34, v35
    v_mfma_f32_16x16x32_bf16 v[64:67], a[240:243], a[36:39], v[64:67]
    ds_read_b64_tr_b16 a[236:237], v148 offset:45056
    v_cvt_pk_bf16_f32 v34, v36, v37
    v_mfma_f32_16x16x32_bf16 v[68:71], a[244:247], a[36:39], v[68:71]
    buffer_load_dwordx4 v145, s[20:23], s45 offen offset:1024 lds
    v_mfma_f32_16x16x32_bf16 v[72:75], a[248:251], a[36:39], v[72:75]
    ds_read_b64_tr_b16 a[238:239], v148 offset:47104
    v_cvt_pk_bf16_f32 v35, v38, v39
    v_mfma_f32_16x16x32_bf16 v[76:79], a[252:255], a[36:39], v[76:79]
    ds_write_b128 v22, v[32:35] offset:0
    v_mfma_f32_16x16x32_bf16 v[80:83], a[240:243], a[40:43], v[80:83]
    v_cvt_pk_bf16_f32 v40, v40, v41
    v_cvt_pk_bf16_f32 v41, v42, v43
    v_mfma_f32_16x16x32_bf16 v[84:87], a[244:247], a[40:43], v[84:87]
    v_cvt_pk_bf16_f32 v42, v44, v45
    v_cvt_pk_bf16_f32 v43, v46, v47
    v_mfma_f32_16x16x32_bf16 v[88:91], a[248:251], a[40:43], v[88:91]
    buffer_load_dwordx4 v146, s[20:23], s45 offen offset:2048 lds
    v_mfma_f32_16x16x32_bf16 v[92:95], a[252:255], a[40:43], v[92:95]
    ds_write_b128 v22, v[40:43] offset:7168
    v_mfma_f32_16x16x32_bf16 v[96:99], a[240:243], a[44:47], v[96:99]
    v_cvt_pk_bf16_f32 v48, v48, v49
    v_cvt_pk_bf16_f32 v49, v50, v51
    v_mfma_f32_16x16x32_bf16 v[100:103], a[244:247], a[44:47], v[100:103]
    v_cvt_pk_bf16_f32 v50, v52, v53
    v_cvt_pk_bf16_f32 v51, v54, v55
    v_mfma_f32_16x16x32_bf16 v[104:107], a[248:251], a[44:47], v[104:107]
    ds_write_b128 v22, v[48:51] offset:1024
    v_mfma_f32_16x16x32_bf16 v[108:111], a[252:255], a[44:47], v[108:111]
    buffer_load_dwordx4 v147, s[20:23], s45 offen offset:3072 lds
    v_mfma_f32_16x16x32_bf16 v[112:115], a[240:243], a[48:51], v[112:115]
    v_cvt_pk_bf16_f32 v56, v56, v57
    v_cvt_pk_bf16_f32 v57, v58, v59
    v_mfma_f32_16x16x32_bf16 v[116:119], a[244:247], a[48:51], v[116:119]
    v_cvt_pk_bf16_f32 v58, v60, v61
    v_cvt_pk_bf16_f32 v59, v62, v63
    v_mfma_f32_16x16x32_bf16 v[120:123], a[248:251], a[48:51], v[120:123]
    ds_write_b128 v22, v[56:59] offset:8192
    v_mfma_f32_16x16x32_bf16 v[124:127], a[252:255], a[48:51], v[124:127]
    v_cvt_pk_bf16_f32 v64, v64, v65
    v_cvt_pk_bf16_f32 v65, v66, v67
    v_mfma_f32_16x16x32_bf16 v[128:131], a[240:243], a[52:55], v[128:131]
    v_cvt_pk_bf16_f32 v66, v68, v69
    v_cvt_pk_bf16_f32 v67, v70, v71
    v_mfma_f32_16x16x32_bf16 v[132:135], a[244:247], a[52:55], v[132:135]
    ds_write_b128 v22, v[64:67] offset:2048
    v_mfma_f32_16x16x32_bf16 v[136:139], a[248:251], a[52:55], v[136:139]
    v_cvt_pk_bf16_f32 v72, v72, v73
    v_cvt_pk_bf16_f32 v73, v74, v75
    v_mfma_f32_16x16x32_bf16 v[140:143], a[252:255], a[52:55], v[140:143]
    v_cvt_pk_bf16_f32 v74, v76, v77
    v_cvt_pk_bf16_f32 v75, v78, v79
    ds_write_b128 v22, v[72:75] offset:9216
    v_cvt_pk_bf16_f32 v80, v80, v81
    v_cvt_pk_bf16_f32 v81, v82, v83
    v_cvt_pk_bf16_f32 v82, v84, v85
    v_cvt_pk_bf16_f32 v83, v86, v87
    ds_write_b128 v22, v[80:83] offset:3072
    v_cvt_pk_bf16_f32 v88, v88, v89
    v_cvt_pk_bf16_f32 v89, v90, v91
    v_cvt_pk_bf16_f32 v90, v92, v93
    v_cvt_pk_bf16_f32 v91, v94, v95
    ds_write_b128 v22, v[88:91] offset:10240
    v_cvt_pk_bf16_f32 v96, v96, v97
    v_cvt_pk_bf16_f32 v97, v98, v99
    v_cvt_pk_bf16_f32 v98, v100, v101
    v_cvt_pk_bf16_f32 v99, v102, v103
    ds_write_b128 v22, v[96:99] offset:4096
    v_cvt_pk_bf16_f32 v104, v104, v105
    v_cvt_pk_bf16_f32 v105, v106, v107
    v_cvt_pk_bf16_f32 v106, v108, v109
    v_cvt_pk_bf16_f32 v107, v110, v111
    ds_write_b128 v22, v[104:107] offset:11264
    v_cvt_pk_bf16_f32 v112, v112, v113
    v_cvt_pk_bf16_f32 v113, v114, v115
    v_cvt_pk_bf16_f32 v114, v116, v117
    v_cvt_pk_bf16_f32 v115, v118, v119
    ds_write_b128 v22, v[112:115] offset:5120
    v_cvt_pk_bf16_f32 v120, v120, v121
    v_cvt_pk_bf16_f32 v121, v122, v123
    v_cvt_pk_bf16_f32 v122, v124, v125
    v_cvt_pk_bf16_f32 v123, v126, v127
    ds_write_b128 v22, v[120:123] offset:12288
    v_cvt_pk_bf16_f32 v128, v128, v129
    v_cvt_pk_bf16_f32 v129, v130, v131
    v_cvt_pk_bf16_f32 v130, v132, v133
    v_cvt_pk_bf16_f32 v131, v134, v135
    ds_write_b128 v22, v[128:131] offset:6144
    v_cvt_pk_bf16_f32 v136, v136, v137
    v_cvt_pk_bf16_f32 v137, v138, v139
    v_cvt_pk_bf16_f32 v138, v140, v141
    v_cvt_pk_bf16_f32 v139, v142, v143
    ds_write_b128 v22, v[136:139] offset:13312
    s_waitcnt lgkmcnt(0)
    s_barrier
    ds_read_b128 a[0:3], v20 offset:0
    ds_read_b128 a[28:31], v20 offset:7168
    ds_read_b128 a[56:59], v20 offset:14336
    ds_read_b128 a[84:87], v20 offset:21504
    ds_read_b128 a[4:7], v20 offset:1024
    ds_read_b128 a[32:35], v20 offset:8192
    ds_read_b128 a[60:63], v20 offset:15360
    ds_read_b128 a[88:91], v20 offset:22528
    ds_read_b128 a[8:11], v20 offset:2048
    ds_read_b128 a[36:39], v20 offset:9216
    s_waitcnt lgkmcnt(9)
    v_mfma_f32_16x16x32_bf16 v[32:35], a[224:227], a[0:3], 0
    ds_read_b128 a[64:67], v20 offset:16384
    s_waitcnt lgkmcnt(9)
    v_mfma_f32_16x16x32_bf16 v[32:35], a[228:231], a[28:31], v[32:35]
    ds_read_b128 a[92:95], v20 offset:23552
    s_waitcnt lgkmcnt(9)
    v_mfma_f32_16x16x32_bf16 v[32:35], a[232:235], a[56:59], v[32:35]
    ds_read_b128 a[12:15], v20 offset:3072
    s_waitcnt lgkmcnt(9)
    v_mfma_f32_16x16x32_bf16 v[32:35], a[236:239], a[84:87], v[32:35]
    ds_read_b128 a[40:43], v20 offset:10240
    s_waitcnt lgkmcnt(7)
    v_mfma_f32_16x16x32_bf16 v[36:39], a[224:227], a[4:7], 0
    ds_read_b128 a[68:71], v20 offset:17408
    v_mfma_f32_16x16x32_bf16 v[36:39], a[228:231], a[32:35], v[36:39]
    ds_read_b128 a[96:99], v20 offset:24576
    v_mfma_f32_16x16x32_bf16 v[36:39], a[232:235], a[60:63], v[36:39]
    ds_read_b128 a[16:19], v20 offset:4096
    s_waitcnt lgkmcnt(6)
    v_mfma_f32_16x16x32_bf16 v[36:39], a[236:239], a[88:91], v[36:39]
    ds_read_b128 a[44:47], v20 offset:11264
    v_mfma_f32_16x16x32_bf16 v[40:43], a[224:227], a[8:11], 0
    ds_read_b128 a[72:75], v20 offset:18432
    v_mfma_f32_16x16x32_bf16 v[40:43], a[228:231], a[36:39], v[40:43]
    ds_read_b128 a[100:103], v20 offset:25600
    v_mfma_f32_16x16x32_bf16 v[40:43], a[232:235], a[64:67], v[40:43]
    ds_read_b128 a[20:23], v20 offset:5120
    s_waitcnt lgkmcnt(7)
    v_mfma_f32_16x16x32_bf16 v[40:43], a[236:239], a[92:95], v[40:43]
    ds_read_b128 a[48:51], v20 offset:12288
    v_mfma_f32_16x16x32_bf16 v[44:47], a[224:227], a[12:15], 0
    ds_read_b128 a[76:79], v20 offset:19456
    v_mfma_f32_16x16x32_bf16 v[44:47], a[228:231], a[40:43], v[44:47]
    ds_read_b128 a[104:107], v20 offset:26624
    s_waitcnt lgkmcnt(7)
    v_mfma_f32_16x16x32_bf16 v[44:47], a[232:235], a[68:71], v[44:47]
    ds_read_b128 a[24:27], v20 offset:6144
    v_mfma_f32_16x16x32_bf16 v[44:47], a[236:239], a[96:99], v[44:47]
    ds_read_b128 a[52:55], v20 offset:13312
    v_mfma_f32_16x16x32_bf16 v[48:51], a[224:227], a[16:19], 0
    ds_read_b128 a[80:83], v20 offset:20480
    s_waitcnt lgkmcnt(7)
    v_mfma_f32_16x16x32_bf16 v[48:51], a[228:231], a[44:47], v[48:51]
    ds_read_b128 a[108:111], v20 offset:27648
    v_mfma_f32_16x16x32_bf16 v[48:51], a[232:235], a[72:75], v[48:51]
    ds_read_b64_tr_b16 a[240:241], v149 offset:16384
    v_mfma_f32_16x16x32_bf16 v[48:51], a[236:239], a[100:103], v[48:51]
    ds_read_b64_tr_b16 a[242:243], v149 offset:18432
    s_waitcnt lgkmcnt(7)
    v_mfma_f32_16x16x32_bf16 v[52:55], a[224:227], a[20:23], 0
    ds_read_b64_tr_b16 a[244:245], v149 offset:20480
    v_mfma_f32_16x16x32_bf16 v[52:55], a[228:231], a[48:51], v[52:55]
    ds_read_b64_tr_b16 a[246:247], v149 offset:22528
    ds_read_b64_tr_b16 a[248:249], v149 offset:40960
    ds_read_b64_tr_b16 a[250:251], v149 offset:43008
    ds_read_b64_tr_b16 a[252:253], v149 offset:45056
    ds_read_b64_tr_b16 a[254:255], v149 offset:47104
    ds_read_b128 a[112:115], v20 offset:28672
    v_mfma_f32_16x16x32_bf16 v[52:55], a[232:235], a[76:79], v[52:55]
    ds_read_b128 a[140:143], v20 offset:35840
    s_waitcnt lgkmcnt(10)
    v_mfma_f32_16x16x32_bf16 v[52:55], a[236:239], a[104:107], v[52:55]
    ds_read_b128 a[168:171], v20 offset:43008
    v_mfma_f32_16x16x32_bf16 v[56:59], a[224:227], a[24:27], 0
    ds_read_b128 a[196:199], v20 offset:50176
    v_mfma_f32_16x16x32_bf16 v[56:59], a[228:231], a[52:55], v[56:59]
    s_add_u32 m0, s37, 16384
    ds_read_b128 a[116:119], v20 offset:29696
    s_add_u32 s45, s43, s56
    v_mfma_f32_16x16x32_bf16 v[56:59], a[232:235], a[80:83], v[56:59]
    ds_read_b128 a[144:147], v20 offset:36864
    v_mfma_f32_16x16x32_bf16 v[56:59], a[236:239], a[108:111], v[56:59]
    ds_read_b128 a[172:175], v20 offset:44032
    s_waitcnt lgkmcnt(6)
    v_mfma_f32_16x16x32_bf16 v[32:35], a[240:243], a[112:115], v[32:35]
    s_waitcnt vmcnt(8)
    s_barrier
    ds_read_b128 a[200:203], v20 offset:51200
    s_waitcnt lgkmcnt(5)
    v_mfma_f32_16x16x32_bf16 v[32:35], a[244:247], a[140:143], v[32:35]
    ds_read_b128 a[120:123], v20 offset:30720
    v_mfma_f32_16x16x32_bf16 v[32:35], a[248:251], a[168:171], v[32:35]
    ds_read_b128 a[148:151], v20 offset:37888
    s_waitcnt lgkmcnt(5)
    v_mfma_f32_16x16x32_bf16 v[32:35], a[252:255], a[196:199], v[32:35]
    ds_read_b128 a[176:179], v20 offset:45056
    v_mfma_f32_16x16x32_bf16 v[36:39], a[240:243], a[116:119], v[36:39]
    ds_read_b128 a[204:207], v20 offset:52224
    buffer_load_dwordx4 v144, s[20:23], s45 offen offset:0 lds
    s_waitcnt lgkmcnt(5)
    v_mfma_f32_16x16x32_bf16 v[36:39], a[244:247], a[144:147], v[36:39]
    ds_read_b128 a[124:127], v20 offset:31744
    v_mfma_f32_16x16x32_bf16 v[36:39], a[248:251], a[172:175], v[36:39]
    ds_read_b128 a[152:155], v20 offset:38912
    buffer_load_dword v196, off, s[28:31], s52
    s_waitcnt lgkmcnt(6)
    v_mfma_f32_16x16x32_bf16 v[36:39], a[252:255], a[200:203], v[36:39]
    ds_read_b128 a[180:183], v20 offset:46080
    s_waitcnt lgkmcnt(5)
    v_mfma_f32_16x16x32_bf16 v[40:43], a[240:243], a[120:123], v[40:43]
    ds_read_b128 a[208:211], v20 offset:53248
    v_mul_f32 v32, v4, v32
    v_mfma_f32_16x16x32_bf16 v[40:43], a[244:247], a[148:151], v[40:43]
    ds_read_b128 a[128:131], v20 offset:32768
    buffer_load_dwordx4 v145, s[20:23], s45 offen offset:1024 lds
    s_waitcnt lgkmcnt(5)
    v_mfma_f32_16x16x32_bf16 v[40:43], a[248:251], a[176:179], v[40:43]
    ds_read_b128 a[156:159], v20 offset:39936
    v_mul_f32 v33, v4, v33
    v_mfma_f32_16x16x32_bf16 v[40:43], a[252:255], a[204:207], v[40:43]
    ds_read_b128 a[184:187], v20 offset:47104
    v_mul_f32 v34, v4, v34
    s_waitcnt lgkmcnt(5)
    v_mfma_f32_16x16x32_bf16 v[44:47], a[240:243], a[124:127], v[44:47]
    ds_read_b128 a[212:215], v20 offset:54272
    v_mul_f32 v35, v4, v35
    v_mfma_f32_16x16x32_bf16 v[44:47], a[244:247], a[152:155], v[44:47]
    ds_read_b128 a[132:135], v20 offset:33792
    v_cvt_pk_bf16_f32 v32, v32, v33
    s_waitcnt lgkmcnt(4)
    v_mfma_f32_16x16x32_bf16 v[44:47], a[248:251], a[180:183], v[44:47]
    s_mul_i32 s46, s53, 112
    ds_read_b128 a[160:163], v20 offset:40960
    buffer_load_dwordx4 v146, s[20:23], s45 offen offset:2048 lds
    v_mfma_f32_16x16x32_bf16 v[44:47], a[252:255], a[208:211], v[44:47]
    s_add_u32 s46, s46, s44
    ds_read_b128 a[188:191], v20 offset:48128
    v_cvt_pk_bf16_f32 v33, v34, v35
    v_mfma_f32_16x16x32_bf16 v[48:51], a[240:243], a[128:131], v[48:51]
    ds_read_b128 a[216:219], v20 offset:55296
    v_mul_f32 v36, v5, v36
    s_waitcnt lgkmcnt(4)
    v_mfma_f32_16x16x32_bf16 v[48:51], a[244:247], a[156:159], v[48:51]
    ds_read_b128 a[136:139], v20 offset:34816
    v_mul_f32 v37, v5, v37
    v_mfma_f32_16x16x32_bf16 v[48:51], a[248:251], a[184:187], v[48:51]
    ds_read_b128 a[164:167], v20 offset:41984
    v_mul_f32 v38, v5, v38
    v_mfma_f32_16x16x32_bf16 v[48:51], a[252:255], a[212:215], v[48:51]
    ds_read_b128 a[192:195], v20 offset:49152
    buffer_load_dwordx4 v147, s[20:23], s45 offen offset:3072 lds
    s_waitcnt lgkmcnt(5)
    v_mfma_f32_16x16x32_bf16 v[52:55], a[240:243], a[132:135], v[52:55]
    s_add_u32 m0, s37, 20480
    ds_read_b128 a[220:223], v20 offset:56320
    s_add_u32 s45, s45, 28672
    v_mfma_f32_16x16x32_bf16 v[52:55], a[244:247], a[160:163], v[52:55]
    ds_read_b64_tr_b16 a[224:225], v148 offset:0
    ds_read_b64_tr_b16 a[226:227], v148 offset:2048
    ds_read_b64_tr_b16 a[228:229], v148 offset:4096
    ds_read_b64_tr_b16 a[230:231], v148 offset:6144
    ds_read_b64_tr_b16 a[232:233], v148 offset:24576
    ds_read_b64_tr_b16 a[234:235], v148 offset:26624
    ds_read_b64_tr_b16 a[236:237], v148 offset:28672
    ds_read_b64_tr_b16 a[238:239], v148 offset:30720
    s_waitcnt lgkmcnt(9)
    v_mfma_f32_16x16x32_bf16 v[52:55], a[248:251], a[188:191], v[52:55]
    buffer_load_dwordx4 v144, s[20:23], s45 offen offset:0 lds
    v_mfma_f32_16x16x32_bf16 v[52:55], a[252:255], a[216:219], v[52:55]
    v_mul_f32 v39, v5, v39
    v_cvt_pk_bf16_f32 v34, v36, v37
    v_mfma_f32_16x16x32_bf16 v[56:59], a[240:243], a[136:139], v[56:59]
    v_cvt_pk_bf16_f32 v35, v38, v39
    v_mul_f32 v40, v6, v40
    v_mfma_f32_16x16x32_bf16 v[56:59], a[244:247], a[164:167], v[56:59]
    v_mul_f32 v41, v6, v41
    v_mfma_f32_16x16x32_bf16 v[56:59], a[248:251], a[192:195], v[56:59]
    buffer_load_dwordx4 v145, s[20:23], s45 offen offset:1024 lds
    s_waitcnt lgkmcnt(2)
    v_mfma_f32_16x16x32_bf16 v[56:59], a[252:255], a[220:223], v[56:59]
    s_waitcnt lgkmcnt(0)
    v_permlane16_swap_b32 v32, v34
    v_mfma_f32_16x16x32_bf16 v[64:67], a[224:227], a[0:3], 0
    ds_read_b64_tr_b16 a[240:241], v149 offset:0
    v_mfma_f32_16x16x32_bf16 v[64:67], a[228:231], a[28:31], v[64:67]
    v_permlane16_swap_b32 v33, v35
    v_mfma_f32_16x16x32_bf16 v[64:67], a[232:235], a[56:59], v[64:67]
    ds_read_b64_tr_b16 a[242:243], v149 offset:2048
    v_mfma_f32_16x16x32_bf16 v[64:67], a[236:239], a[84:87], v[64:67]
    buffer_load_dwordx4 v146, s[20:23], s45 offen offset:2048 lds
    v_mfma_f32_16x16x32_bf16 v[68:71], a[224:227], a[4:7], 0
    ds_read_b64_tr_b16 a[244:245], v149 offset:4096
    v_mfma_f32_16x16x32_bf16 v[68:71], a[228:231], a[32:35], v[68:71]
    buffer_store_dwordx4 v[32:35], v151, s[32:35], s46 offen offset:0 sc1
    v_mfma_f32_16x16x32_bf16 v[68:71], a[232:235], a[60:63], v[68:71]
    ds_read_b64_tr_b16 a[246:247], v149 offset:6144
    v_mul_f32 v42, v6, v42
    v_mfma_f32_16x16x32_bf16 v[68:71], a[236:239], a[88:91], v[68:71]
    v_mul_f32 v43, v6, v43
    v_cvt_pk_bf16_f32 v40, v40, v41
    v_mfma_f32_16x16x32_bf16 v[72:75], a[224:227], a[8:11], 0
    buffer_load_dwordx4 v147, s[20:23], s45 offen offset:3072 lds
    v_mfma_f32_16x16x32_bf16 v[72:75], a[228:231], a[36:39], v[72:75]
    ds_read_b64_tr_b16 a[248:249], v149 offset:24576
    v_cvt_pk_bf16_f32 v41, v42, v43
    v_mfma_f32_16x16x32_bf16 v[72:75], a[232:235], a[64:67], v[72:75]
    ds_read_b64_tr_b16 a[250:251], v149 offset:26624
    v_mul_f32 v44, v7, v44
    v_mfma_f32_16x16x32_bf16 v[72:75], a[236:239], a[92:95], v[72:75]
    v_mul_f32 v45, v7, v45
    v_mul_f32 v46, v7, v46
    v_mfma_f32_16x16x32_bf16 v[76:79], a[224:227], a[12:15], 0
    ds_read_b64_tr_b16 a[252:253], v149 offset:28672
    v_mul_f32 v47, v7, v47
    v_mfma_f32_16x16x32_bf16 v[76:79], a[228:231], a[40:43], v[76:79]
    v_cvt_pk_bf16_f32 v42, v44, v45
    v_cvt_pk_bf16_f32 v43, v46, v47
    v_mfma_f32_16x16x32_bf16 v[76:79], a[232:235], a[68:71], v[76:79]
    ds_read_b64_tr_b16 a[254:255], v149 offset:30720
    v_mul_f32 v48, v8, v48
    v_mfma_f32_16x16x32_bf16 v[76:79], a[236:239], a[96:99], v[76:79]
    v_mul_f32 v49, v8, v49
    v_mfma_f32_16x16x32_bf16 v[80:83], a[224:227], a[16:19], 0
    v_permlane16_swap_b32 v40, v42
    v_mfma_f32_16x16x32_bf16 v[80:83], a[228:231], a[44:47], v[80:83]
    v_permlane16_swap_b32 v41, v43
    v_mfma_f32_16x16x32_bf16 v[80:83], a[232:235], a[72:75], v[80:83]
    buffer_store_dwordx4 v[40:43], v151, s[32:35], s46 offen offset:1024 sc1
    v_mfma_f32_16x16x32_bf16 v[80:83], a[236:239], a[100:103], v[80:83]
    v_mul_f32 v50, v8, v50
    v_mul_f32 v51, v8, v51
    v_mfma_f32_16x16x32_bf16 v[84:87], a[224:227], a[20:23], 0
    v_cvt_pk_bf16_f32 v48, v48, v49
    v_cvt_pk_bf16_f32 v49, v50, v51
    v_mfma_f32_16x16x32_bf16 v[84:87], a[228:231], a[48:51], v[84:87]
    v_mul_f32 v52, v9, v52
    v_mul_f32 v53, v9, v53
    v_mfma_f32_16x16x32_bf16 v[84:87], a[232:235], a[76:79], v[84:87]
    v_mul_f32 v54, v9, v54
    v_mul_f32 v55, v9, v55
    v_mfma_f32_16x16x32_bf16 v[84:87], a[236:239], a[104:107], v[84:87]
    v_cvt_pk_bf16_f32 v50, v52, v53
    v_cvt_pk_bf16_f32 v51, v54, v55
    v_mfma_f32_16x16x32_bf16 v[88:91], a[224:227], a[24:27], 0
    v_mul_f32 v56, v10, v56
    v_mul_f32 v57, v10, v57
    v_permlane16_swap_b32 v48, v50
    v_permlane16_swap_b32 v49, v51
    buffer_store_dwordx4 v[48:51], v151, s[32:35], s46 offen offset:2048 sc1
    v_mul_f32 v58, v10, v58
    v_mul_f32 v59, v10, v59
    v_cvt_pk_bf16_f32 v56, v56, v57
    v_cvt_pk_bf16_f32 v57, v58, v59
    buffer_store_dwordx2 v[56:57], v150, s[32:35], s46 offen offset:3072 sc1
    v_mfma_f32_16x16x32_bf16 v[88:91], a[228:231], a[52:55], v[88:91]
    s_add_u32 m0, s37, 0
    s_add_u32 s45, s43, s57
    v_mfma_f32_16x16x32_bf16 v[88:91], a[232:235], a[80:83], v[88:91]
    v_mfma_f32_16x16x32_bf16 v[88:91], a[236:239], a[108:111], v[88:91]
    s_waitcnt lgkmcnt(0)
    v_mfma_f32_16x16x32_bf16 v[64:67], a[240:243], a[112:115], v[64:67]
    s_waitcnt vmcnt(13)
    s_barrier
    ds_read_b64_tr_b16 a[224:225], v148 offset:8192
    v_mfma_f32_16x16x32_bf16 v[64:67], a[244:247], a[140:143], v[64:67]
    buffer_load_dwordx4 v144, s[20:23], s45 offen offset:0 lds
    v_mfma_f32_16x16x32_bf16 v[64:67], a[248:251], a[168:171], v[64:67]
    ds_read_b64_tr_b16 a[226:227], v148 offset:10240
    v_mfma_f32_16x16x32_bf16 v[64:67], a[252:255], a[196:199], v[64:67]
    v_mfma_f32_16x16x32_bf16 v[68:71], a[240:243], a[116:119], v[68:71]
    ds_read_b64_tr_b16 a[228:229], v148 offset:12288
    v_mfma_f32_16x16x32_bf16 v[68:71], a[244:247], a[144:147], v[68:71]
    v_mfma_f32_16x16x32_bf16 v[68:71], a[248:251], a[172:175], v[68:71]
    buffer_load_dwordx4 v145, s[20:23], s45 offen offset:1024 lds
    v_mfma_f32_16x16x32_bf16 v[68:71], a[252:255], a[200:203], v[68:71]
    ds_read_b64_tr_b16 a[230:231], v148 offset:14336
    v_mfma_f32_16x16x32_bf16 v[72:75], a[240:243], a[120:123], v[72:75]
    ds_read_b64_tr_b16 a[232:233], v148 offset:32768
    v_mul_f32 v64, v4, v64
    v_mfma_f32_16x16x32_bf16 v[72:75], a[244:247], a[148:151], v[72:75]
    v_mul_f32 v65, v4, v65
    v_mul_f32 v66, v4, v66
    v_mfma_f32_16x16x32_bf16 v[72:75], a[248:251], a[176:179], v[72:75]
    ds_read_b64_tr_b16 a[234:235], v148 offset:34816
    v_mul_f32 v67, v4, v67
    v_mfma_f32_16x16x32_bf16 v[72:75], a[252:255], a[204:207], v[72:75]
    buffer_load_dwordx4 v146, s[20:23], s45 offen offset:2048 lds
    v_mfma_f32_16x16x32_bf16 v[76:79], a[240:243], a[124:127], v[76:79]
    ds_read_b64_tr_b16 a[236:237], v148 offset:36864
    v_cvt_pk_bf16_f32 v64, v64, v65
    v_mfma_f32_16x16x32_bf16 v[76:79], a[244:247], a[152:155], v[76:79]
    s_mul_i32 s46, s54, 112
    s_add_u32 s46, s46, s44
    v_cvt_pk_bf16_f32 v65, v66, v67
    v_mfma_f32_16x16x32_bf16 v[76:79], a[248:251], a[180:183], v[76:79]
    ds_read_b64_tr_b16 a[238:239], v148 offset:38912
    v_mul_f32 v68, v5, v68
    v_mfma_f32_16x16x32_bf16 v[76:79], a[252:255], a[208:211], v[76:79]
    v_mul_f32 v69, v5, v69
    v_mul_f32 v70, v5, v70
    v_mfma_f32_16x16x32_bf16 v[80:83], a[240:243], a[128:131], v[80:83]
    buffer_load_dwordx4 v147, s[20:23], s45 offen offset:3072 lds
    v_mfma_f32_16x16x32_bf16 v[80:83], a[244:247], a[156:159], v[80:83]
    s_add_u32 m0, s37, 4096
    s_add_u32 s45, s45, 28672
    v_mul_f32 v71, v5, v71
    v_mfma_f32_16x16x32_bf16 v[80:83], a[248:251], a[184:187], v[80:83]
    v_cvt_pk_bf16_f32 v66, v68, v69
    v_cvt_pk_bf16_f32 v67, v70, v71
    v_mfma_f32_16x16x32_bf16 v[80:83], a[252:255], a[212:215], v[80:83]
    v_mul_f32 v72, v6, v72
    v_mul_f32 v73, v6, v73
    v_mfma_f32_16x16x32_bf16 v[84:87], a[240:243], a[132:135], v[84:87]
    v_permlane16_swap_b32 v64, v66
    v_mfma_f32_16x16x32_bf16 v[84:87], a[244:247], a[160:163], v[84:87]
    buffer_load_dwordx4 v144, s[20:23], s45 offen offset:0 lds
    v_mfma_f32_16x16x32_bf16 v[84:87], a[248:251], a[188:191], v[84:87]
    v_permlane16_swap_b32 v65, v67
    v_mfma_f32_16x16x32_bf16 v[84:87], a[252:255], a[216:219], v[84:87]
    buffer_store_dwordx4 v[64:67], v151, s[32:35], s46 offen offset:0 sc1
    v_mfma_f32_16x16x32_bf16 v[88:91], a[240:243], a[136:139], v[88:91]
    v_mul_f32 v74, v6, v74
    v_mul_f32 v75, v6, v75
    v_mfma_f32_16x16x32_bf16 v[88:91], a[244:247], a[164:167], v[88:91]
    v_cvt_pk_bf16_f32 v72, v72, v73
    v_cvt_pk_bf16_f32 v73, v74, v75
    v_mfma_f32_16x16x32_bf16 v[88:91], a[248:251], a[192:195], v[88:91]
    buffer_load_dwordx4 v145, s[20:23], s45 offen offset:1024 lds
    v_mfma_f32_16x16x32_bf16 v[88:91], a[252:255], a[220:223], v[88:91]
    s_waitcnt lgkmcnt(0)
    v_mul_f32 v76, v7, v76
    v_mul_f32 v77, v7, v77
    v_mfma_f32_16x16x32_bf16 v[32:35], a[224:227], a[0:3], 0
    s_waitcnt vmcnt(18)
    ds_read_b64_tr_b16 a[240:241], v149 offset:8192
    v_readfirstlane_b32 s60, v196
    v_mfma_f32_16x16x32_bf16 v[32:35], a[228:231], a[28:31], v[32:35]
    s_cmp_eq_u32 s60, 1
    s_cbranch_scc0 L_census
L_census_ok:
    v_mul_f32 v78, v7, v78
    v_mfma_f32_16x16x32_bf16 v[32:35], a[232:235], a[56:59], v[32:35]
    ds_read_b64_tr_b16 a[242:243], v149 offset:10240
    v_mul_f32 v79, v7, v79
    v_mfma_f32_16x16x32_bf16 v[32:35], a[236:239], a[84:87], v[32:35]
    buffer_load_dwordx4 v146, s[20:23], s45 offen offset:2048 lds
    v_mfma_f32_16x16x32_bf16 v[36:39], a[224:227], a[4:7], 0
    ds_read_b64_tr_b16 a[244:245], v149 offset:12288
    v_cvt_pk_bf16_f32 v74, v76, v77
    v_mfma_f32_16x16x32_bf16 v[36:39], a[228:231], a[32:35], v[36:39]
    v_cvt_pk_bf16_f32 v75, v78, v79
    v_mul_f32 v80, v8, v80
    v_mfma_f32_16x16x32_bf16 v[36:39], a[232:235], a[60:63], v[36:39]
    ds_read_b64_tr_b16 a[246:247], v149 offset:14336
    v_mul_f32 v81, v8, v81
    v_mfma_f32_16x16x32_bf16 v[36:39], a[236:239], a[88:91], v[36:39]
    v_permlane16_swap_b32 v72, v74
    v_mfma_f32_16x16x32_bf16 v[40:43], a[224:227], a[8:11], 0
    buffer_load_dwordx4 v147, s[20:23], s45 offen offset:3072 lds
    v_mfma_f32_16x16x32_bf16 v[40:43], a[228:231], a[36:39], v[40:43]
    ds_read_b64_tr_b16 a[248:249], v149 offset:32768
    v_mfma_f32_16x16x32_bf16 v[40:43], a[232:235], a[64:67], v[40:43]
    ds_read_b64_tr_b16 a[250:251], v149 offset:34816
    v_mfma_f32_16x16x32_bf16 v[40:43], a[236:239], a[92:95], v[40:43]
    v_permlane16_swap_b32 v73, v75
    v_mfma_f32_16x16x32_bf16 v[44:47], a[224:227], a[12:15], 0
    ds_read_b64_tr_b16 a[252:253], v149 offset:36864
    v_mfma_f32_16x16x32_bf16 v[44:47], a[228:231], a[40:43], v[44:47]
    buffer_store_dwordx4 v[72:75], v151, s[32:35], s46 offen offset:1024 sc1
    v_mfma_f32_16x16x32_bf16 v[44:47], a[232:235], a[68:71], v[44:47]
    ds_read_b64_tr_b16 a[254:255], v149 offset:38912
    v_mul_f32 v82, v8, v82
    v_mfma_f32_16x16x32_bf16 v[44:47], a[236:239], a[96:99], v[44:47]
    v_mul_f32 v83, v8, v83
    v_cvt_pk_bf16_f32 v80, v80, v81
    v_mfma_f32_16x16x32_bf16 v[48:51], a[224:227], a[16:19], 0
    v_cvt_pk_bf16_f32 v81, v82, v83
    v_mul_f32 v84, v9, v84
    v_mfma_f32_16x16x32_bf16 v[48:51], a[228:231], a[44:47], v[48:51]
    v_mul_f32 v85, v9, v85
    v_mul_f32 v86, v9, v86
    v_mfma_f32_16x16x32_bf16 v[48:51], a[232:235], a[72:75], v[48:51]
    v_mul_f32 v87, v9, v87
    v_cvt_pk_bf16_f32 v82, v84, v85
    v_mfma_f32_16x16x32_bf16 v[48:51], a[236:239], a[100:103], v[48:51]
    v_cvt_pk_bf16_f32 v83, v86, v87
    v_mul_f32 v88, v10, v88
    v_mfma_f32_16x16x32_bf16 v[52:55], a[224:227], a[20:23], 0
    v_mul_f32 v89, v10, v89
    v_mfma_f32_16x16x32_bf16 v[52:55], a[228:231], a[48:51], v[52:55]
    v_permlane16_swap_b32 v80, v82
    v_mfma_f32_16x16x32_bf16 v[52:55], a[232:235], a[76:79], v[52:55]
    v_permlane16_swap_b32 v81, v83
    v_mfma_f32_16x16x32_bf16 v[52:55], a[236:239], a[104:107], v[52:55]
    buffer_store_dwordx4 v[80:83], v151, s[32:35], s46 offen offset:2048 sc1
    v_mfma_f32_16x16x32_bf16 v[56:59], a[224:227], a[24:27], 0
    v_mul_f32 v90, v10, v90
    v_mul_f32 v91, v10, v91
    v_cvt_pk_bf16_f32 v88, v88, v89
    v_cvt_pk_bf16_f32 v89, v90, v91
    buffer_store_dwordx2 v[88:89], v150, s[32:35], s46 offen offset:3072 sc1
    v_mfma_f32_16x16x32_bf16 v[56:59], a[228:231], a[52:55], v[56:59]
    s_add_u32 m0, s37, 8192
    s_add_u32 s45, s43, s58
    v_mfma_f32_16x16x32_bf16 v[56:59], a[232:235], a[80:83], v[56:59]
    v_mfma_f32_16x16x32_bf16 v[56:59], a[236:239], a[108:111], v[56:59]
    s_waitcnt lgkmcnt(0)
    v_mfma_f32_16x16x32_bf16 v[32:35], a[240:243], a[112:115], v[32:35]
    s_waitcnt vmcnt(15)
    s_barrier
    ds_read_b64_tr_b16 a[224:225], v148 offset:16384
    v_mfma_f32_16x16x32_bf16 v[32:35], a[244:247], a[140:143], v[32:35]
    buffer_load_dwordx4 v144, s[20:23], s45 offen offset:0 lds
    v_mfma_f32_16x16x32_bf16 v[32:35], a[248:251], a[168:171], v[32:35]
    ds_read_b64_tr_b16 a[226:227], v148 offset:18432
    v_mfma_f32_16x16x32_bf16 v[32:35], a[252:255], a[196:199], v[32:35]
    v_mfma_f32_16x16x32_bf16 v[36:39], a[240:243], a[116:119], v[36:39]
    ds_read_b64_tr_b16 a[228:229], v148 offset:20480
    v_mfma_f32_16x16x32_bf16 v[36:39], a[244:247], a[144:147], v[36:39]
    v_mfma_f32_16x16x32_bf16 v[36:39], a[248:251], a[172:175], v[36:39]
    buffer_load_dwordx4 v145, s[20:23], s45 offen offset:1024 lds
    v_mfma_f32_16x16x32_bf16 v[36:39], a[252:255], a[200:203], v[36:39]
    ds_read_b64_tr_b16 a[230:231], v148 offset:22528
    v_mfma_f32_16x16x32_bf16 v[40:43], a[240:243], a[120:123], v[40:43]
    ds_read_b64_tr_b16 a[232:233], v148 offset:40960
    v_mul_f32 v32, v4, v32
    v_mfma_f32_16x16x32_bf16 v[40:43], a[244:247], a[148:151], v[40:43]
    v_mul_f32 v33, v4, v33
    v_mul_f32 v34, v4, v34
    v_mfma_f32_16x16x32_bf16 v[40:43], a[248:251], a[176:179], v[40:43]
    ds_read_b64_tr_b16 a[234:235], v148 offset:43008
    v_mul_f32 v35, v4, v35
    v_mfma_f32_16x16x32_bf16 v[40:43], a[252:255], a[204:207], v[40:43]
    buffer_load_dwordx4 v146, s[20:23], s45 offen offset:2048 lds
    v_mfma_f32_16x16x32_bf16 v[44:47], a[240:243], a[124:127], v[44:47]
    ds_read_b64_tr_b16 a[236:237], v148 offset:45056
    v_cvt_pk_bf16_f32 v32, v32, v33
    v_mfma_f32_16x16x32_bf16 v[44:47], a[244:247], a[152:155], v[44:47]
    s_mul_i32 s46, s55, 112
    s_add_u32 s46, s46, s44
    v_cvt_pk_bf16_f32 v33, v34, v35
    v_mfma_f32_16x16x32_bf16 v[44:47], a[248:251], a[180:183], v[44:47]
    ds_read_b64_tr_b16 a[238:239], v148 offset:47104
    v_mul_f32 v36, v5, v36
    v_mfma_f32_16x16x32_bf16 v[44:47], a[252:255], a[208:211], v[44:47]
    v_mul_f32 v37, v5, v37
    v_mul_f32 v38, v5, v38
    v_mfma_f32_16x16x32_bf16 v[48:51], a[240:243], a[128:131], v[48:51]
    buffer_load_dwordx4 v147, s[20:23], s45 offen offset:3072 lds
    v_mfma_f32_16x16x32_bf16 v[48:51], a[244:247], a[156:159], v[48:51]
    s_add_u32 m0, s37, 12288
    s_add_u32 s45, s45, 28672
    v_mul_f32 v39, v5, v39
    v_mfma_f32_16x16x32_bf16 v[48:51], a[248:251], a[184:187], v[48:51]
    v_cvt_pk_bf16_f32 v34, v36, v37
    v_cvt_pk_bf16_f32 v35, v38, v39
    v_mfma_f32_16x16x32_bf16 v[48:51], a[252:255], a[212:215], v[48:51]
    v_mul_f32 v40, v6, v40
    v_mul_f32 v41, v6, v41
    v_mfma_f32_16x16x32_bf16 v[52:55], a[240:243], a[132:135], v[52:55]
    v_permlane16_swap_b32 v32, v34
    v_mfma_f32_16x16x32_bf16 v[52:55], a[244:247], a[160:163], v[52:55]
    buffer_load_dwordx4 v144, s[20:23], s45 offen offset:0 lds
    v_mfma_f32_16x16x32_bf16 v[52:55], a[248:251], a[188:191], v[52:55]
    v_permlane16_swap_b32 v33, v35
    v_mfma_f32_16x16x32_bf16 v[52:55], a[252:255], a[216:219], v[52:55]
    buffer_store_dwordx4 v[32:35], v151, s[32:35], s46 offen offset:0 sc1
    v_mfma_f32_16x16x32_bf16 v[56:59], a[240:243], a[136:139], v[56:59]
    v_mul_f32 v42, v6, v42
    v_mul_f32 v43, v6, v43
    v_mfma_f32_16x16x32_bf16 v[56:59], a[244:247], a[164:167], v[56:59]
    v_cvt_pk_bf16_f32 v40, v40, v41
    v_cvt_pk_bf16_f32 v41, v42, v43
    v_mfma_f32_16x16x32_bf16 v[56:59], a[248:251], a[192:195], v[56:59]
    buffer_load_dwordx4 v145, s[20:23], s45 offen offset:1024 lds
    v_mfma_f32_16x16x32_bf16 v[56:59], a[252:255], a[220:223], v[56:59]
    s_waitcnt lgkmcnt(0)
    v_mul_f32 v44, v7, v44
    v_mul_f32 v45, v7, v45
    v_mfma_f32_16x16x32_bf16 v[64:67], a[224:227], a[0:3], 0
    ds_read_b64_tr_b16 a[240:241], v149 offset:16384
    v_mul_f32 v46, v7, v46
    v_mfma_f32_16x16x32_bf16 v[64:67], a[228:231], a[28:31], v[64:67]
    v_mul_f32 v47, v7, v47
    v_cvt_pk_bf16_f32 v42, v44, v45
    v_mfma_f32_16x16x32_bf16 v[64:67], a[232:235], a[56:59], v[64:67]
    ds_read_b64_tr_b16 a[242:243], v149 offset:18432
    v_cvt_pk_bf16_f32 v43, v46, v47
    v_mfma_f32_16x16x32_bf16 v[64:67], a[236:239], a[84:87], v[64:67]
    buffer_load_dwordx4 v146, s[20:23], s45 offen offset:2048 lds
    v_mfma_f32_16x16x32_bf16 v[68:71], a[224:227], a[4:7], 0
    ds_read_b64_tr_b16 a[244:245], v149 offset:20480
    v_mul_f32 v48, v8, v48
    v_mfma_f32_16x16x32_bf16 v[68:71], a[228:231], a[32:35], v[68:71]
    v_mul_f32 v49, v8, v49
    v_mfma_f32_16x16x32_bf16 v[68:71], a[232:235], a[60:63], v[68:71]
    ds_read_b64_tr_b16 a[246:247], v149 offset:22528
    v_mfma_f32_16x16x32_bf16 v[68:71], a[236:239], a[88:91], v[68:71]
    v_permlane16_swap_b32 v40, v42
    v_mfma_f32_16x16x32_bf16 v[72:75], a[224:227], a[8:11], 0
    buffer_load_dwordx4 v147, s[20:23], s45 offen offset:3072 lds
    v_mfma_f32_16x16x32_bf16 v[72:75], a[228:231], a[36:39], v[72:75]
    ds_read_b64_tr_b16 a[248:249], v149 offset:40960
    v_mfma_f32_16x16x32_bf16 v[72:75], a[232:235], a[64:67], v[72:75]
    ds_read_b64_tr_b16 a[250:251], v149 offset:43008
    v_mfma_f32_16x16x32_bf16 v[72:75], a[236:239], a[92:95], v[72:75]
    v_permlane16_swap_b32 v41, v43
    v_mfma_f32_16x16x32_bf16 v[76:79], a[224:227], a[12:15], 0
    ds_read_b64_tr_b16 a[252:253], v149 offset:45056
    v_mfma_f32_16x16x32_bf16 v[76:79], a[228:231], a[40:43], v[76:79]
    buffer_store_dwordx4 v[40:43], v151, s[32:35], s46 offen offset:1024 sc1
    v_mfma_f32_16x16x32_bf16 v[76:79], a[232:235], a[68:71], v[76:79]
    ds_read_b64_tr_b16 a[254:255], v149 offset:47104
    v_mul_f32 v50, v8, v50
    v_mfma_f32_16x16x32_bf16 v[76:79], a[236:239], a[96:99], v[76:79]
    v_mul_f32 v51, v8, v51
    v_cvt_pk_bf16_f32 v48, v48, v49
    v_mfma_f32_16x16x32_bf16 v[80:83], a[224:227], a[16:19], 0
    v_cvt_pk_bf16_f32 v49, v50, v51
    v_mul_f32 v52, v9, v52
    v_mfma_f32_16x16x32_bf16 v[80:83], a[228:231], a[44:47], v[80:83]
    v_mul_f32 v53, v9, v53
    v_mul_f32 v54, v9, v54
    v_mfma_f32_16x16x32_bf16 v[80:83], a[232:235], a[72:75], v[80:83]
    v_mul_f32 v55, v9, v55
    v_cvt_pk_bf16_f32 v50, v52, v53
    v_mfma_f32_16x16x32_bf16 v[80:83], a[236:239], a[100:103], v[80:83]
    v_cvt_pk_bf16_f32 v51, v54, v55
    v_mul_f32 v56, v10, v56
    v_mfma_f32_16x16x32_bf16 v[84:87], a[224:227], a[20:23], 0
    v_mul_f32 v57, v10, v57
    v_mfma_f32_16x16x32_bf16 v[84:87], a[228:231], a[48:51], v[84:87]
    v_permlane16_swap_b32 v48, v50
    v_mfma_f32_16x16x32_bf16 v[84:87], a[232:235], a[76:79], v[84:87]
    v_permlane16_swap_b32 v49, v51
    v_mfma_f32_16x16x32_bf16 v[84:87], a[236:239], a[104:107], v[84:87]
    buffer_store_dwordx4 v[48:51], v151, s[32:35], s46 offen offset:2048 sc1
    v_mfma_f32_16x16x32_bf16 v[88:91], a[224:227], a[24:27], 0
    v_mul_f32 v58, v10, v58
    v_mul_f32 v59, v10, v59
    v_cvt_pk_bf16_f32 v56, v56, v57
    v_cvt_pk_bf16_f32 v57, v58, v59
    buffer_store_dwordx2 v[56:57], v150, s[32:35], s46 offen offset:3072 sc1
    v_mfma_f32_16x16x32_bf16 v[88:91], a[228:231], a[52:55], v[88:91]
    s_add_u32 m0, s37, 16384
    s_add_u32 s45, s43, s59
    v_mfma_f32_16x16x32_bf16 v[88:91], a[232:235], a[80:83], v[88:91]
    v_mfma_f32_16x16x32_bf16 v[88:91], a[236:239], a[108:111], v[88:91]
    s_waitcnt lgkmcnt(0)
    v_mfma_f32_16x16x32_bf16 v[64:67], a[240:243], a[112:115], v[64:67]
    s_waitcnt vmcnt(15)
    s_barrier
    ds_read_b64_tr_b16 a[224:225], v148 offset:0
    v_mfma_f32_16x16x32_bf16 v[64:67], a[244:247], a[140:143], v[64:67]
    buffer_load_dwordx4 v144, s[20:23], s45 offen offset:0 lds
    v_mfma_f32_16x16x32_bf16 v[64:67], a[248:251], a[168:171], v[64:67]
    ds_read_b64_tr_b16 a[226:227], v148 offset:2048
    v_mfma_f32_16x16x32_bf16 v[64:67], a[252:255], a[196:199], v[64:67]
    v_mfma_f32_16x16x32_bf16 v[68:71], a[240:243], a[116:119], v[68:71]
    ds_read_b64_tr_b16 a[228:229], v148 offset:4096
    v_and_b32 v160, 15, v0
    v_mfma_f32_16x16x32_bf16 v[68:71], a[244:247], a[144:147], v[68:71]
    v_lshrrev_b32 v161, 4, v0
    s_lshl1_add_u32 s99, s49, s50
    v_mfma_f32_16x16x32_bf16 v[68:71], a[248:251], a[172:175], v[68:71]
    buffer_load_dwordx4 v145, s[20:23], s45 offen offset:1024 lds
    v_mfma_f32_16x16x32_bf16 v[68:71], a[252:255], a[200:203], v[68:71]
    s_and_b32 s99, s99, 15
    ds_read_b64_tr_b16 a[230:231], v148 offset:6144
    s_mul_i32 s61, s36, 3584
    v_mfma_f32_16x16x32_bf16 v[72:75], a[240:243], a[120:123], v[72:75]
    s_lshl_b32 s62, s99, 8
    ds_read_b64_tr_b16 a[232:233], v148 offset:24576
    v_mul_f32 v64, v4, v64
    v_mfma_f32_16x16x32_bf16 v[72:75], a[244:247], a[148:151], v[72:75]
    s_add_u32 s61, s61, s62
    v_mul_f32 v65, v4, v65
    v_mul_f32 v66, v4, v66
    v_mfma_f32_16x16x32_bf16 v[72:75], a[248:251], a[176:179], v[72:75]
    ds_read_b64_tr_b16 a[234:235], v148 offset:26624
    v_mul_f32 v67, v4, v67
    v_mfma_f32_16x16x32_bf16 v[72:75], a[252:255], a[204:207], v[72:75]
    buffer_load_dwordx4 v146, s[20:23], s45 offen offset:2048 lds
    v_mfma_f32_16x16x32_bf16 v[76:79], a[240:243], a[124:127], v[76:79]
    ds_read_b64_tr_b16 a[236:237], v148 offset:28672
    v_cvt_pk_bf16_f32 v64, v64, v65
    v_mfma_f32_16x16x32_bf16 v[76:79], a[244:247], a[152:155], v[76:79]
    s_mul_i32 s46, s56, 112
    s_add_u32 s46, s46, s44
    v_cvt_pk_bf16_f32 v65, v66, v67
    v_mfma_f32_16x16x32_bf16 v[76:79], a[248:251], a[180:183], v[76:79]
    ds_read_b64_tr_b16 a[238:239], v148 offset:30720
    v_mul_f32 v68, v5, v68
    v_mfma_f32_16x16x32_bf16 v[76:79], a[252:255], a[208:211], v[76:79]
    v_mul_f32 v69, v5, v69
    v_mul_f32 v70, v5, v70
    v_mfma_f32_16x16x32_bf16 v[80:83], a[240:243], a[128:131], v[80:83]
    buffer_load_dwordx4 v147, s[20:23], s45 offen offset:3072 lds
    v_mfma_f32_16x16x32_bf16 v[80:83], a[244:247], a[156:159], v[80:83]
    s_add_u32 m0, s37, 20480
    s_add_u32 s45, s45, 28672
    v_mul_f32 v71, v5, v71
    v_mfma_f32_16x16x32_bf16 v[80:83], a[248:251], a[184:187], v[80:83]
    v_cvt_pk_bf16_f32 v66, v68, v69
    v_cvt_pk_bf16_f32 v67, v70, v71
    v_mfma_f32_16x16x32_bf16 v[80:83], a[252:255], a[212:215], v[80:83]
    v_mul_f32 v72, v6, v72
    v_mul_f32 v73, v6, v73
    v_mfma_f32_16x16x32_bf16 v[84:87], a[240:243], a[132:135], v[84:87]
    v_permlane16_swap_b32 v64, v66
    v_mfma_f32_16x16x32_bf16 v[84:87], a[244:247], a[160:163], v[84:87]
    buffer_load_dwordx4 v144, s[20:23], s45 offen offset:0 lds
    v_mfma_f32_16x16x32_bf16 v[84:87], a[248:251], a[188:191], v[84:87]
    v_permlane16_swap_b32 v65, v67
    v_mfma_f32_16x16x32_bf16 v[84:87], a[252:255], a[216:219], v[84:87]
    buffer_store_dwordx4 v[64:67], v151, s[32:35], s46 offen offset:0 sc1
    v_mfma_f32_16x16x32_bf16 v[88:91], a[240:243], a[136:139], v[88:91]
    v_mul_f32 v74, v6, v74
    v_mul_f32 v75, v6, v75
    v_mfma_f32_16x16x32_bf16 v[88:91], a[244:247], a[164:167], v[88:91]
    v_cvt_pk_bf16_f32 v72, v72, v73
    v_cvt_pk_bf16_f32 v73, v74, v75
    v_mfma_f32_16x16x32_bf16 v[88:91], a[248:251], a[192:195], v[88:91]
    buffer_load_dwordx4 v145, s[20:23], s45 offen offset:1024 lds
    v_mfma_f32_16x16x32_bf16 v[88:91], a[252:255], a[220:223], v[88:91]
    s_waitcnt lgkmcnt(0)
    v_mul_f32 v76, v7, v76
    v_mul_f32 v77, v7, v77
    v_mfma_f32_16x16x32_bf16 v[32:35], a[224:227], a[0:3], 0
    ds_read_b64_tr_b16 a[240:241], v149 offset:0
    v_mul_f32 v78, v7, v78
    v_mfma_f32_16x16x32_bf16 v[32:35], a[228:231], a[28:31], v[32:35]
    v_mul_f32 v79, v7, v79
    v_cvt_pk_bf16_f32 v74, v76, v77
    v_mfma_f32_16x16x32_bf16 v[32:35], a[232:235], a[56:59], v[32:35]
    ds_read_b64_tr_b16 a[242:243], v149 offset:2048
    v_cvt_pk_bf16_f32 v75, v78, v79
    v_mfma_f32_16x16x32_bf16 v[32:35], a[236:239], a[84:87], v[32:35]
    buffer_load_dwordx4 v146, s[20:23], s45 offen offset:2048 lds
    v_mfma_f32_16x16x32_bf16 v[36:39], a[224:227], a[4:7], 0
    ds_read_b64_tr_b16 a[244:245], v149 offset:4096
    v_mul_f32 v80, v8, v80
    v_mfma_f32_16x16x32_bf16 v[36:39], a[228:231], a[32:35], v[36:39]
    v_mul_f32 v81, v8, v81
    v_mul_u32_u24 v164, 100352, v161
    v_mfma_f32_16x16x32_bf16 v[36:39], a[232:235], a[60:63], v[36:39]
    ds_read_b64_tr_b16 a[246:247], v149 offset:6144
    v_lshl_add_u32 v164, v160, 4, v164
    v_mfma_f32_16x16x32_bf16 v[36:39], a[236:239], a[88:91], v[36:39]
    v_permlane16_swap_b32 v72, v74
    v_mfma_f32_16x16x32_bf16 v[40:43], a[224:227], a[8:11], 0
    buffer_load_dwordx4 v147, s[20:23], s45 offen offset:3072 lds
    v_mfma_f32_16x16x32_bf16 v[40:43], a[228:231], a[36:39], v[40:43]
    s_cmp_lt_u32 s99, 14
    s_cselect_b32 s61, s61, 0x40000000
    ds_read_b64_tr_b16 a[248:249], v149 offset:24576
    v_mfma_f32_16x16x32_bf16 v[40:43], a[232:235], a[64:67], v[40:43]
    ds_read_b64_tr_b16 a[250:251], v149 offset:26624
    v_add_u32 v152, s61, v164
    v_mfma_f32_16x16x32_bf16 v[40:43], a[236:239], a[92:95], v[40:43]
    v_permlane16_swap_b32 v73, v75
    v_mfma_f32_16x16x32_bf16 v[44:47], a[224:227], a[12:15], 0
    ds_read_b64_tr_b16 a[252:253], v149 offset:28672
    v_add_u32 v153, 401408, v152
    v_mfma_f32_16x16x32_bf16 v[44:47], a[228:231], a[40:43], v[44:47]
    buffer_store_dwordx4 v[72:75], v151, s[32:35], s46 offen offset:1024 sc1
    v_mfma_f32_16x16x32_bf16 v[44:47], a[232:235], a[68:71], v[44:47]
    ds_read_b64_tr_b16 a[254:255], v149 offset:30720
    v_mul_f32 v82, v8, v82
    v_mfma_f32_16x16x32_bf16 v[44:47], a[236:239], a[96:99], v[44:47]
    v_mul_f32 v83, v8, v83
    v_cvt_pk_bf16_f32 v80, v80, v81
    v_mfma_f32_16x16x32_bf16 v[48:51], a[224:227], a[16:19], 0
    v_cvt_pk_bf16_f32 v81, v82, v83
    v_mul_f32 v84, v9, v84
    v_mfma_f32_16x16x32_bf16 v[48:51], a[228:231], a[44:47], v[48:51]
    v_mul_f32 v85, v9, v85
    v_mul_f32 v86, v9, v86
    v_mfma_f32_16x16x32_bf16 v[48:51], a[232:235], a[72:75], v[48:51]
    v_mul_f32 v87, v9, v87
    v_cvt_pk_bf16_f32 v82, v84, v85
    v_mfma_f32_16x16x32_bf16 v[48:51], a[236:239], a[100:103], v[48:51]
    v_cvt_pk_bf16_f32 v83, v86, v87
    v_mul_f32 v88, v10, v88
    v_mfma_f32_16x16x32_bf16 v[52:55], a[224:227], a[20:23], 0
    v_mul_f32 v89, v10, v89
    v_add_u32 v154, 802816, v152
    v_mfma_f32_16x16x32_bf16 v[52:55], a[228:231], a[48:51], v[52:55]
    v_permlane16_swap_b32 v80, v82
    v_mfma_f32_16x16x32_bf16 v[52:55], a[232:235], a[76:79], v[52:55]
    v_permlane16_swap_b32 v81, v83
    v_mfma_f32_16x16x32_bf16 v[52:55], a[236:239], a[104:107], v[52:55]
    buffer_store_dwordx4 v[80:83], v151, s[32:35], s46 offen offset:2048 sc1
    v_mfma_f32_16x16x32_bf16 v[56:59], a[224:227], a[24:27], 0
    v_mul_f32 v90, v10, v90
    v_mul_f32 v91, v10, v91
    v_cvt_pk_bf16_f32 v88, v88, v89
    v_cvt_pk_bf16_f32 v89, v90, v91
    buffer_store_dwordx2 v[88:89], v150, s[32:35], s46 offen offset:3072 sc1
    v_mfma_f32_16x16x32_bf16 v[56:59], a[228:231], a[52:55], v[56:59]
    v_add_u32 v155, 1204224, v152
    s_lshl_b32 s63, s99, 7
    v_mfma_f32_16x16x32_bf16 v[56:59], a[232:235], a[80:83], v[56:59]
    v_lshlrev_b32 v169, 2, v160
    v_add_u32 v169, s63, v169
    v_mfma_f32_16x16x32_bf16 v[56:59], a[236:239], a[108:111], v[56:59]
    s_waitcnt lgkmcnt(0)
    v_mov_b32 v2, 3
    v_lshrrev_b32 v162, 1, v160
    v_mfma_f32_16x16x32_bf16 v[32:35], a[240:243], a[112:115], v[32:35]
    s_waitcnt vmcnt(15)
    s_barrier
    ds_read_b64_tr_b16 a[224:225], v148 offset:8192
    v_mfma_f32_16x16x32_bf16 v[32:35], a[244:247], a[140:143], v[32:35]
    v_mul_u32_u24 v164, 896, v162
    v_and_b32 v163, 1, v160
    v_mfma_f32_16x16x32_bf16 v[32:35], a[248:251], a[168:171], v[32:35]
    ds_read_b64_tr_b16 a[226:227], v148 offset:10240
    v_lshl_add_u32 v164, v163, 4, v164
    v_mfma_f32_16x16x32_bf16 v[32:35], a[252:255], a[196:199], v[32:35]
    s_waitcnt vmcnt(12)
    v_and_b32 v163, 1, v161
    v_lshl_add_u32 v164, v163, 3, v164
    v_mfma_f32_16x16x32_bf16 v[36:39], a[240:243], a[116:119], v[36:39]
    buffer_store_dword v2, v3, s[32:35], s65 offen offset:0 sc1
    v_mfma_f32_16x16x32_bf16 v[36:39], a[244:247], a[144:147], v[36:39]
    s_mul_i32 s62, s99, 7168
    ds_read_b64_tr_b16 a[228:229], v148 offset:12288
    s_lshl_b32 s63, s36, 5
    v_mfma_f32_16x16x32_bf16 v[36:39], a[248:251], a[172:175], v[36:39]
    s_add_u32 s62, s62, s63
    ds_read_b64_tr_b16 a[230:231], v148 offset:14336
    v_add_u32 v164, s62, v164
    v_mfma_f32_16x16x32_bf16 v[36:39], a[252:255], a[200:203], v[36:39]
    v_mov_b32 v165, 0x40000000
    v_mfma_f32_16x16x32_bf16 v[40:43], a[240:243], a[120:123], v[40:43]
    ds_read_b64_tr_b16 a[232:233], v148 offset:32768
    v_mul_f32 v32, v4, v32
    v_mfma_f32_16x16x32_bf16 v[40:43], a[244:247], a[148:151], v[40:43]
    v_mul_f32 v33, v4, v33
    v_mul_f32 v34, v4, v34
    v_mfma_f32_16x16x32_bf16 v[40:43], a[248:251], a[176:179], v[40:43]
    ds_read_b64_tr_b16 a[234:235], v148 offset:34816
    v_mul_f32 v35, v4, v35
    v_mfma_f32_16x16x32_bf16 v[40:43], a[252:255], a[204:207], v[40:43]
    v_cvt_pk_bf16_f32 v32, v32, v33
    s_mul_i32 s46, s57, 112
    v_mfma_f32_16x16x32_bf16 v[44:47], a[240:243], a[124:127], v[44:47]
    s_add_u32 s46, s46, s44
    ds_read_b64_tr_b16 a[236:237], v148 offset:36864
    v_cvt_pk_bf16_f32 v33, v34, v35
    v_mfma_f32_16x16x32_bf16 v[44:47], a[244:247], a[152:155], v[44:47]
    v_mul_f32 v36, v5, v36
    v_mul_f32 v37, v5, v37
    v_mfma_f32_16x16x32_bf16 v[44:47], a[248:251], a[180:183], v[44:47]
    ds_read_b64_tr_b16 a[238:239], v148 offset:38912
    v_mul_f32 v38, v5, v38
    v_mfma_f32_16x16x32_bf16 v[44:47], a[252:255], a[208:211], v[44:47]
    v_mul_f32 v39, v5, v39
    v_cvt_pk_bf16_f32 v34, v36, v37
    v_mfma_f32_16x16x32_bf16 v[48:51], a[240:243], a[128:131], v[48:51]
    v_cvt_pk_bf16_f32 v35, v38, v39
    v_mul_f32 v40, v6, v40
    v_mfma_f32_16x16x32_bf16 v[48:51], a[244:247], a[156:159], v[48:51]
    v_mul_f32 v41, v6, v41
    v_mfma_f32_16x16x32_bf16 v[48:51], a[248:251], a[184:187], v[48:51]
    v_permlane16_swap_b32 v32, v34
    v_mfma_f32_16x16x32_bf16 v[48:51], a[252:255], a[212:215], v[48:51]
    v_permlane16_swap_b32 v33, v35
    v_mfma_f32_16x16x32_bf16 v[52:55], a[240:243], a[132:135], v[52:55]
    buffer_store_dwordx4 v[32:35], v151, s[32:35], s46 offen offset:0 sc1
    v_mfma_f32_16x16x32_bf16 v[52:55], a[244:247], a[160:163], v[52:55]
    v_mul_f32 v42, v6, v42
    v_mul_f32 v43, v6, v43
    v_mfma_f32_16x16x32_bf16 v[52:55], a[248:251], a[188:191], v[52:55]
    v_cvt_pk_bf16_f32 v40, v40, v41
    v_cvt_pk_bf16_f32 v41, v42, v43
    v_mfma_f32_16x16x32_bf16 v[52:55], a[252:255], a[216:219], v[52:55]
    v_mul_f32 v44, v7, v44
    v_mul_f32 v45, v7, v45
    v_mfma_f32_16x16x32_bf16 v[56:59], a[240:243], a[136:139], v[56:59]
    v_mul_f32 v46, v7, v46
    v_mul_f32 v47, v7, v47
    v_mfma_f32_16x16x32_bf16 v[56:59], a[244:247], a[164:167], v[56:59]
    v_cvt_pk_bf16_f32 v42, v44, v45
    v_cvt_pk_bf16_f32 v43, v46, v47
    v_mfma_f32_16x16x32_bf16 v[56:59], a[248:251], a[192:195], v[56:59]
    v_mul_f32 v48, v8, v48
    v_mul_f32 v49, v8, v49
    v_mfma_f32_16x16x32_bf16 v[56:59], a[252:255], a[220:223], v[56:59]
    s_waitcnt lgkmcnt(0)
    v_permlane16_swap_b32 v40, v42
    v_mfma_f32_16x16x32_bf16 v[64:67], a[224:227], a[0:3], 0
    ds_read_b64_tr_b16 a[240:241], v149 offset:8192
    v_mfma_f32_16x16x32_bf16 v[64:67], a[228:231], a[28:31], v[64:67]
    v_permlane16_swap_b32 v41, v43
    v_mfma_f32_16x16x32_bf16 v[64:67], a[232:235], a[56:59], v[64:67]
    ds_read_b64_tr_b16 a[242:243], v149 offset:10240
    v_mfma_f32_16x16x32_bf16 v[64:67], a[236:239], a[84:87], v[64:67]
    buffer_store_dwordx4 v[40:43], v151, s[32:35], s46 offen offset:1024 sc1
    v_mfma_f32_16x16x32_bf16 v[68:71], a[224:227], a[4:7], 0
    ds_read_b64_tr_b16 a[244:245], v149 offset:12288
    v_mul_f32 v50, v8, v50
    v_mfma_f32_16x16x32_bf16 v[68:71], a[228:231], a[32:35], v[68:71]
    v_mul_f32 v51, v8, v51
    v_cvt_pk_bf16_f32 v48, v48, v49
    v_mfma_f32_16x16x32_bf16 v[68:71], a[232:235], a[60:63], v[68:71]
    ds_read_b64_tr_b16 a[246:247], v149 offset:14336
    v_cvt_pk_bf16_f32 v49, v50, v51
    v_mfma_f32_16x16x32_bf16 v[68:71], a[236:239], a[88:91], v[68:71]
    v_mul_f32 v52, v9, v52
    v_mul_f32 v53, v9, v53
    v_mfma_f32_16x16x32_bf16 v[72:75], a[224:227], a[8:11], 0
    ds_read_b64_tr_b16 a[248:249], v149 offset:32768
    v_mul_f32 v54, v9, v54
    v_mfma_f32_16x16x32_bf16 v[72:75], a[228:231], a[36:39], v[72:75]
    v_mul_f32 v55, v9, v55
    v_cvt_pk_bf16_f32 v50, v52, v53
    v_mfma_f32_16x16x32_bf16 v[72:75], a[232:235], a[64:67], v[72:75]
    ds_read_b64_tr_b16 a[250:251], v149 offset:34816
    v_cvt_pk_bf16_f32 v51, v54, v55
    v_mfma_f32_16x16x32_bf16 v[72:75], a[236:239], a[92:95], v[72:75]
    v_mul_f32 v56, v10, v56
    v_mul_f32 v57, v10, v57
    v_mfma_f32_16x16x32_bf16 v[76:79], a[224:227], a[12:15], 0
    ds_read_b64_tr_b16 a[252:253], v149 offset:36864
    v_mfma_f32_16x16x32_bf16 v[76:79], a[228:231], a[40:43], v[76:79]
    v_permlane16_swap_b32 v48, v50
    v_mfma_f32_16x16x32_bf16 v[76:79], a[232:235], a[68:71], v[76:79]
    ds_read_b64_tr_b16 a[254:255], v149 offset:38912
    v_mfma_f32_16x16x32_bf16 v[76:79], a[236:239], a[96:99], v[76:79]
    v_permlane16_swap_b32 v49, v51
    v_mfma_f32_16x16x32_bf16 v[80:83], a[224:227], a[16:19], 0
    buffer_store_dwordx4 v[48:51], v151, s[32:35], s46 offen offset:2048 sc1
    v_mfma_f32_16x16x32_bf16 v[80:83], a[228:231], a[44:47], v[80:83]
    v_mul_f32 v58, v10, v58
    v_mul_f32 v59, v10, v59
    v_mfma_f32_16x16x32_bf16 v[80:83], a[232:235], a[72:75], v[80:83]
    v_cvt_pk_bf16_f32 v56, v56, v57
    v_cvt_pk_bf16_f32 v57, v58, v59
    v_mfma_f32_16x16x32_bf16 v[80:83], a[236:239], a[100:103], v[80:83]
    buffer_store_dwordx2 v[56:57], v150, s[32:35], s46 offen offset:3072 sc1
    v_mfma_f32_16x16x32_bf16 v[84:87], a[224:227], a[20:23], 0
    v_cmp_gt_u32 vcc, 2, v161
    s_nop 1
    v_mfma_f32_16x16x32_bf16 v[84:87], a[228:231], a[48:51], v[84:87]
    v_mov_b32 v166, s53
    v_mov_b32 v163, s54
    v_mfma_f32_16x16x32_bf16 v[84:87], a[232:235], a[76:79], v[84:87]
    v_cndmask_b32 v166, v163, v166, vcc
    v_add_u32 v156, v166, v164
    v_mfma_f32_16x16x32_bf16 v[84:87], a[236:239], a[104:107], v[84:87]
    v_mov_b32 v166, s55
    v_mov_b32 v163, s56
    v_mfma_f32_16x16x32_bf16 v[88:91], a[224:227], a[24:27], 0
    v_cndmask_b32 v166, v163, v166, vcc
    v_add_u32 v157, v166, v164
    v_mfma_f32_16x16x32_bf16 v[88:91], a[228:231], a[52:55], v[88:91]
    v_mov_b32 v166, s57
    v_mov_b32 v163, s58
    v_mfma_f32_16x16x32_bf16 v[88:91], a[232:235], a[80:83], v[88:91]
    v_cndmask_b32 v166, v163, v166, vcc
    v_add_u32 v158, v166, v164
    v_mfma_f32_16x16x32_bf16 v[88:91], a[236:239], a[108:111], v[88:91]
    s_waitcnt lgkmcnt(0)
    v_mov_b32 v166, s59
    v_cndmask_b32 v166, v165, v166, vcc
    v_mfma_f32_16x16x32_bf16 v[64:67], a[240:243], a[112:115], v[64:67]
    s_waitcnt vmcnt(8)
    s_barrier
    ds_read_b64_tr_b16 a[224:225], v148 offset:16384
    v_mfma_f32_16x16x32_bf16 v[64:67], a[244:247], a[140:143], v[64:67]
    v_add_u32 v159, v166, v164
    v_and_b32 v163, 1, v160
    v_mfma_f32_16x16x32_bf16 v[64:67], a[248:251], a[168:171], v[64:67]
    ds_read_b64_tr_b16 a[226:227], v148 offset:18432
    v_lshlrev_b32 v163, 4, v163
    v_mfma_f32_16x16x32_bf16 v[64:67], a[252:255], a[196:199], v[64:67]
    v_mov_b32 v166, 0x3f80
    v_lshlrev_b32 v163, v163, v166
    v_mfma_f32_16x16x32_bf16 v[68:71], a[240:243], a[116:119], v[68:71]
    ds_read_b64_tr_b16 a[228:229], v148 offset:20480
    v_mfma_f32_16x16x32_bf16 v[68:71], a[244:247], a[144:147], v[68:71]
    v_cmp_eq_u32 vcc, 0, v162
    s_nop 1
    v_mfma_f32_16x16x32_bf16 v[68:71], a[248:251], a[172:175], v[68:71]
    ds_read_b64_tr_b16 a[230:231], v148 offset:22528
    v_cndmask_b32 v172, 0, v163, vcc
    v_mfma_f32_16x16x32_bf16 v[68:71], a[252:255], a[200:203], v[68:71]
    v_cmp_eq_u32 vcc, 1, v162
    s_nop 1
    v_mfma_f32_16x16x32_bf16 v[72:75], a[240:243], a[120:123], v[72:75]
    ds_read_b64_tr_b16 a[232:233], v148 offset:40960
    v_mul_f32 v64, v4, v64
    v_mfma_f32_16x16x32_bf16 v[72:75], a[244:247], a[148:151], v[72:75]
    v_mul_f32 v65, v4, v65
    v_mul_f32 v66, v4, v66
    v_mfma_f32_16x16x32_bf16 v[72:75], a[248:251], a[176:179], v[72:75]
    ds_read_b64_tr_b16 a[234:235], v148 offset:43008
    v_mul_f32 v67, v4, v67
    v_mfma_f32_16x16x32_bf16 v[72:75], a[252:255], a[204:207], v[72:75]
    v_cvt_pk_bf16_f32 v64, v64, v65
    s_mul_i32 s46, s58, 112
    v_mfma_f32_16x16x32_bf16 v[76:79], a[240:243], a[124:127], v[76:79]
    s_add_u32 s46, s46, s44
    ds_read_b64_tr_b16 a[236:237], v148 offset:45056
    v_cvt_pk_bf16_f32 v65, v66, v67
    v_mfma_f32_16x16x32_bf16 v[76:79], a[244:247], a[152:155], v[76:79]
    v_mul_f32 v68, v5, v68
    v_mul_f32 v69, v5, v69
    v_mfma_f32_16x16x32_bf16 v[76:79], a[248:251], a[180:183], v[76:79]
    ds_read_b64_tr_b16 a[238:239], v148 offset:47104
    v_mul_f32 v70, v5, v70
    v_mfma_f32_16x16x32_bf16 v[76:79], a[252:255], a[208:211], v[76:79]
    v_mul_f32 v71, v5, v71
    v_cvt_pk_bf16_f32 v66, v68, v69
    v_mfma_f32_16x16x32_bf16 v[80:83], a[240:243], a[128:131], v[80:83]
    v_cvt_pk_bf16_f32 v67, v70, v71
    v_mul_f32 v72, v6, v72
    v_mfma_f32_16x16x32_bf16 v[80:83], a[244:247], a[156:159], v[80:83]
    v_mul_f32 v73, v6, v73
    v_cndmask_b32 v173, 0, v163, vcc
    v_mfma_f32_16x16x32_bf16 v[80:83], a[248:251], a[184:187], v[80:83]
    v_permlane16_swap_b32 v64, v66
    v_mfma_f32_16x16x32_bf16 v[80:83], a[252:255], a[212:215], v[80:83]
    v_permlane16_swap_b32 v65, v67
    v_mfma_f32_16x16x32_bf16 v[84:87], a[240:243], a[132:135], v[84:87]
    buffer_store_dwordx4 v[64:67], v151, s[32:35], s46 offen offset:0 sc1
    v_mfma_f32_16x16x32_bf16 v[84:87], a[244:247], a[160:163], v[84:87]
    v_mul_f32 v74, v6, v74
    v_mul_f32 v75, v6, v75
    v_mfma_f32_16x16x32_bf16 v[84:87], a[248:251], a[188:191], v[84:87]
    v_cvt_pk_bf16_f32 v72, v72, v73
    v_cvt_pk_bf16_f32 v73, v74, v75
    v_mfma_f32_16x16x32_bf16 v[84:87], a[252:255], a[216:219], v[84:87]
    v_mul_f32 v76, v7, v76
    v_mul_f32 v77, v7, v77
    v_mfma_f32_16x16x32_bf16 v[88:91], a[240:243], a[136:139], v[88:91]
    v_mul_f32 v78, v7, v78
    v_mul_f32 v79, v7, v79
    v_mfma_f32_16x16x32_bf16 v[88:91], a[244:247], a[164:167], v[88:91]
    v_cvt_pk_bf16_f32 v74, v76, v77
    v_cvt_pk_bf16_f32 v75, v78, v79
    v_mfma_f32_16x16x32_bf16 v[88:91], a[248:251], a[192:195], v[88:91]
    v_mul_f32 v80, v8, v80
    v_mul_f32 v81, v8, v81
    v_mfma_f32_16x16x32_bf16 v[88:91], a[252:255], a[220:223], v[88:91]
    s_waitcnt lgkmcnt(0)
    v_permlane16_swap_b32 v72, v74
    v_mfma_f32_16x16x32_bf16 v[32:35], a[224:227], a[0:3], 0
    ds_read_b64_tr_b16 a[240:241], v149 offset:16384
    v_mfma_f32_16x16x32_bf16 v[32:35], a[228:231], a[28:31], v[32:35]
    v_permlane16_swap_b32 v73, v75
    v_mfma_f32_16x16x32_bf16 v[32:35], a[232:235], a[56:59], v[32:35]
    ds_read_b64_tr_b16 a[242:243], v149 offset:18432
    v_mfma_f32_16x16x32_bf16 v[32:35], a[236:239], a[84:87], v[32:35]
    buffer_store_dwordx4 v[72:75], v151, s[32:35], s46 offen offset:1024 sc1
    v_mfma_f32_16x16x32_bf16 v[36:39], a[224:227], a[4:7], 0
    ds_read_b64_tr_b16 a[244:245], v149 offset:20480
    v_mul_f32 v82, v8, v82
    v_mfma_f32_16x16x32_bf16 v[36:39], a[228:231], a[32:35], v[36:39]
    v_mul_f32 v83, v8, v83
    v_cvt_pk_bf16_f32 v80, v80, v81
    v_mfma_f32_16x16x32_bf16 v[36:39], a[232:235], a[60:63], v[36:39]
    ds_read_b64_tr_b16 a[246:247], v149 offset:22528
    v_cvt_pk_bf16_f32 v81, v82, v83
    v_mfma_f32_16x16x32_bf16 v[36:39], a[236:239], a[88:91], v[36:39]
    v_mul_f32 v84, v9, v84
    v_mul_f32 v85, v9, v85
    v_mfma_f32_16x16x32_bf16 v[40:43], a[224:227], a[8:11], 0
    ds_read_b64_tr_b16 a[248:249], v149 offset:40960
    v_mul_f32 v86, v9, v86
    v_mfma_f32_16x16x32_bf16 v[40:43], a[228:231], a[36:39], v[40:43]
    v_mul_f32 v87, v9, v87
    v_cvt_pk_bf16_f32 v82, v84, v85
    v_mfma_f32_16x16x32_bf16 v[40:43], a[232:235], a[64:67], v[40:43]
    ds_read_b64_tr_b16 a[250:251], v149 offset:43008
    v_cvt_pk_bf16_f32 v83, v86, v87
    v_mfma_f32_16x16x32_bf16 v[40:43], a[236:239], a[92:95], v[40:43]
    v_mul_f32 v88, v10, v88
    v_mul_f32 v89, v10, v89
    v_mfma_f32_16x16x32_bf16 v[44:47], a[224:227], a[12:15], 0
    ds_read_b64_tr_b16 a[252:253], v149 offset:45056
    v_mfma_f32_16x16x32_bf16 v[44:47], a[228:231], a[40:43], v[44:47]
    v_permlane16_swap_b32 v80, v82
    v_mfma_f32_16x16x32_bf16 v[44:47], a[232:235], a[68:71], v[44:47]
    ds_read_b64_tr_b16 a[254:255], v149 offset:47104
    v_mfma_f32_16x16x32_bf16 v[44:47], a[236:239], a[96:99], v[44:47]
    v_permlane16_swap_b32 v81, v83
    v_mfma_f32_16x16x32_bf16 v[48:51], a[224:227], a[16:19], 0
    buffer_store_dwordx4 v[80:83], v151, s[32:35], s46 offen offset:2048 sc1
    v_mfma_f32_16x16x32_bf16 v[48:51], a[228:231], a[44:47], v[48:51]
    v_mul_f32 v90, v10, v90
    v_mul_f32 v91, v10, v91
    v_mfma_f32_16x16x32_bf16 v[48:51], a[232:235], a[72:75], v[48:51]
    v_cvt_pk_bf16_f32 v88, v88, v89
    v_cvt_pk_bf16_f32 v89, v90, v91
    v_mfma_f32_16x16x32_bf16 v[48:51], a[236:239], a[100:103], v[48:51]
    buffer_store_dwordx2 v[88:89], v150, s[32:35], s46 offen offset:3072 sc1
    v_mfma_f32_16x16x32_bf16 v[52:55], a[224:227], a[20:23], 0
    v_cmp_eq_u32 vcc, 2, v162
    s_nop 1
    v_mfma_f32_16x16x32_bf16 v[52:55], a[228:231], a[48:51], v[52:55]
    v_cndmask_b32 v174, 0, v163, vcc
    v_mfma_f32_16x16x32_bf16 v[52:55], a[232:235], a[76:79], v[52:55]
    v_cmp_eq_u32 vcc, 3, v162
    s_nop 1
    v_mfma_f32_16x16x32_bf16 v[52:55], a[236:239], a[104:107], v[52:55]
    v_cndmask_b32 v175, 0, v163, vcc
    v_mfma_f32_16x16x32_bf16 v[56:59], a[224:227], a[24:27], 0
    v_cmp_eq_u32 vcc, 4, v162
    s_nop 1
    v_mfma_f32_16x16x32_bf16 v[56:59], a[228:231], a[52:55], v[56:59]
    v_cndmask_b32 v176, 0, v163, vcc
    v_mfma_f32_16x16x32_bf16 v[56:59], a[232:235], a[80:83], v[56:59]
    v_cmp_eq_u32 vcc, 5, v162
    s_nop 1
    v_mfma_f32_16x16x32_bf16 v[56:59], a[236:239], a[108:111], v[56:59]
    s_waitcnt lgkmcnt(0)
    v_cndmask_b32 v177, 0, v163, vcc
    v_mfma_f32_16x16x32_bf16 v[32:35], a[240:243], a[112:115], v[32:35]
    v_cmp_eq_u32 vcc, 6, v162
    s_nop 1
    v_mfma_f32_16x16x32_bf16 v[32:35], a[244:247], a[140:143], v[32:35]
    v_cndmask_b32 v178, 0, v163, vcc
    v_mfma_f32_16x16x32_bf16 v[32:35], a[248:251], a[168:171], v[32:35]
    v_cmp_eq_u32 vcc, 7, v162
    s_nop 1
    v_mfma_f32_16x16x32_bf16 v[32:35], a[252:255], a[196:199], v[32:35]
    v_cndmask_b32 v179, 0, v163, vcc
    s_mul_i32 s64, s49, 1605632
    v_mfma_f32_16x16x32_bf16 v[36:39], a[240:243], a[116:119], v[36:39]
    v_mfma_f32_16x16x32_bf16 v[36:39], a[244:247], a[144:147], v[36:39]
    v_mfma_f32_16x16x32_bf16 v[36:39], a[248:251], a[172:175], v[36:39]
    v_mfma_f32_16x16x32_bf16 v[36:39], a[252:255], a[200:203], v[36:39]
    v_mfma_f32_16x16x32_bf16 v[40:43], a[240:243], a[120:123], v[40:43]
    s_nop 0
    v_mul_f32 v32, v4, v32
    v_mul_f32 v33, v4, v33
    v_mfma_f32_16x16x32_bf16 v[40:43], a[244:247], a[148:151], v[40:43]
    v_mul_f32 v34, v4, v34
    v_mul_f32 v35, v4, v35
    v_mfma_f32_16x16x32_bf16 v[40:43], a[248:251], a[176:179], v[40:43]
    v_cvt_pk_bf16_f32 v32, v32, v33
    s_mul_i32 s46, s59, 112
    v_mfma_f32_16x16x32_bf16 v[40:43], a[252:255], a[204:207], v[40:43]
    s_add_u32 s46, s46, s44
    v_cvt_pk_bf16_f32 v33, v34, v35
    v_mfma_f32_16x16x32_bf16 v[44:47], a[240:243], a[124:127], v[44:47]
    v_mul_f32 v36, v5, v36
    v_mul_f32 v37, v5, v37
    v_mfma_f32_16x16x32_bf16 v[44:47], a[244:247], a[152:155], v[44:47]
    v_mul_f32 v38, v5, v38
    v_mul_f32 v39, v5, v39
    v_mfma_f32_16x16x32_bf16 v[44:47], a[248:251], a[180:183], v[44:47]
    v_cvt_pk_bf16_f32 v34, v36, v37
    v_cvt_pk_bf16_f32 v35, v38, v39
    v_mfma_f32_16x16x32_bf16 v[44:47], a[252:255], a[208:211], v[44:47]
    v_mfma_f32_16x16x32_bf16 v[48:51], a[240:243], a[128:131], v[48:51]
    v_mul_f32 v40, v6, v40
    v_mul_f32 v41, v6, v41
    v_mfma_f32_16x16x32_bf16 v[48:51], a[244:247], a[156:159], v[48:51]
    v_permlane16_swap_b32 v32, v34
    v_mfma_f32_16x16x32_bf16 v[48:51], a[248:251], a[184:187], v[48:51]
    v_permlane16_swap_b32 v33, v35
    v_mfma_f32_16x16x32_bf16 v[48:51], a[252:255], a[212:215], v[48:51]
    buffer_store_dwordx4 v[32:35], v151, s[32:35], s46 offen offset:0 sc1
    v_mfma_f32_16x16x32_bf16 v[52:55], a[240:243], a[132:135], v[52:55]
    v_mul_f32 v42, v6, v42
    v_mul_f32 v43, v6, v43
    v_mfma_f32_16x16x32_bf16 v[52:55], a[244:247], a[160:163], v[52:55]
    v_cvt_pk_bf16_f32 v40, v40, v41
    v_cvt_pk_bf16_f32 v41, v42, v43
    v_mfma_f32_16x16x32_bf16 v[52:55], a[248:251], a[188:191], v[52:55]
    v_mul_f32 v44, v7, v44
    v_mul_f32 v45, v7, v45
    v_mfma_f32_16x16x32_bf16 v[52:55], a[252:255], a[216:219], v[52:55]
    v_mul_f32 v46, v7, v46
    v_mul_f32 v47, v7, v47
    v_mfma_f32_16x16x32_bf16 v[56:59], a[240:243], a[136:139], v[56:59]
    v_cvt_pk_bf16_f32 v42, v44, v45
    v_cvt_pk_bf16_f32 v43, v46, v47
    v_mfma_f32_16x16x32_bf16 v[56:59], a[244:247], a[164:167], v[56:59]
    v_mul_f32 v48, v8, v48
    v_mul_f32 v49, v8, v49
    v_mfma_f32_16x16x32_bf16 v[56:59], a[248:251], a[192:195], v[56:59]
    v_permlane16_swap_b32 v40, v42
    v_mfma_f32_16x16x32_bf16 v[56:59], a[252:255], a[220:223], v[56:59]
    v_permlane16_swap_b32 v41, v43
    buffer_store_dwordx4 v[40:43], v151, s[32:35], s46 offen offset:1024 sc1
    v_mul_f32 v50, v8, v50
    v_mul_f32 v51, v8, v51
    v_cvt_pk_bf16_f32 v48, v48, v49
    v_cvt_pk_bf16_f32 v49, v50, v51
    v_mul_f32 v52, v9, v52
    v_mul_f32 v53, v9, v53
    v_mul_f32 v54, v9, v54
    v_mul_f32 v55, v9, v55
    v_cvt_pk_bf16_f32 v50, v52, v53
    v_cvt_pk_bf16_f32 v51, v54, v55
    v_mul_f32 v56, v10, v56
    v_mul_f32 v57, v10, v57
    v_permlane16_swap_b32 v48, v50
    v_permlane16_swap_b32 v49, v51
    buffer_store_dwordx4 v[48:51], v151, s[32:35], s46 offen offset:2048 sc1
    v_mul_f32 v58, v10, v58
    v_mul_f32 v59, v10, v59
    v_cvt_pk_bf16_f32 v56, v56, v57
    v_cvt_pk_bf16_f32 v57, v58, v59
    buffer_store_dwordx2 v[56:57], v150, s[32:35], s46 offen offset:3072 sc1
    s_mov_b32 s61, 0x40000
    v_mov_b32 v2, 7
    s_cmp_lt_u32 s99, 14
    s_cbranch_scc1 L_busy
    s_waitcnt vmcnt(0)
    buffer_store_dword v2, v3, s[32:35], s65 offen sc1
    s_branch L_tail_end
L_busy:
    buffer_load_dword v200, v169, s[32:35], s65 offen offset:0 sc1
    s_waitcnt vmcnt(1)
    buffer_store_dword v2, v3, s[32:35], s65 offen offset:0 sc1
    s_waitcnt vmcnt(1)
    v_cmp_le_u32 vcc, 3, v200
    s_cmp_eq_u64 vcc, -1
    s_cbranch_scc1 L_spin_e_x
L_spin_e:
    buffer_load_dword v200, v169, s[32:35], s65 offen sc1
    s_sub_u32 s61, s61, 1
    s_waitcnt vmcnt(0)
    v_cmp_le_u32 vcc, 3, v200
    s_cmp_eq_u64 vcc, -1
    s_cbranch_scc1 L_spin_e_x
    s_cmp_gt_u32 s61, 7
    s_cbranch_scc1 L_spin_e
L_spin_e_x:
    v_mov_b32 v201, v200
L_e2_f0:
    s_mul_i32 s62, s53, 112
    s_add_u32 s62, s62, s64
    buffer_load_dwordx4 v[96:99], v152, s[32:35], s62 offen offset:0 sc1
    buffer_load_dwordx4 v[100:103], v153, s[32:35], s62 offen offset:0 sc1
    buffer_load_dwordx4 v[104:107], v154, s[32:35], s62 offen offset:0 sc1
    buffer_load_dwordx4 v[108:111], v155, s[32:35], s62 offen offset:0 sc1
L_e2_f1:
    s_mul_i32 s62, s54, 112
    s_add_u32 s62, s62, s64
    buffer_load_dwordx4 v[112:115], v152, s[32:35], s62 offen offset:0 sc1
    buffer_load_dwordx4 v[116:119], v153, s[32:35], s62 offen offset:0 sc1
    buffer_load_dwordx4 v[120:123], v154, s[32:35], s62 offen offset:0 sc1
    buffer_load_dwordx4 v[124:127], v155, s[32:35], s62 offen offset:0 sc1
L_e2_f2:
    s_mul_i32 s62, s55, 112
    s_add_u32 s62, s62, s64
    buffer_load_dwordx4 v[128:131], v152, s[32:35], s62 offen offset:0 sc1
    buffer_load_dwordx4 v[132:135], v153, s[32:35], s62 offen offset:0 sc1
    buffer_load_dwordx4 v[136:139], v154, s[32:35], s62 offen offset:0 sc1
    buffer_load_dwordx4 v[140:143], v155, s[32:35], s62 offen offset:0 sc1
L_e2_f3:
    buffer_load_dword v200, v169, s[32:35], s65 offen offset:0 sc1
    s_waitcnt vmcnt(0)
    v_cmp_le_u32 vcc, 7, v200
    s_cmp_eq_u64 vcc, -1
    s_cbranch_scc1 L_spin_l_x
L_spin_l:
    buffer_load_dword v200, v169, s[32:35], s65 offen sc1
    s_sub_u32 s61, s61, 1
    s_waitcnt vmcnt(0)
    v_cmp_le_u32 vcc, 7, v200
    s_cmp_eq_u64 vcc, -1
    s_cbranch_scc1 L_spin_l_x
    s_cmp_gt_u32 s61, 7
    s_cbranch_scc1 L_spin_l
L_spin_l_x:
    s_mul_i32 s62, s56, 112
    s_add_u32 s62, s62, s64
    buffer_load_dwordx4 v[208:211], v152, s[32:35], s62 offen offset:0 sc1
    buffer_load_dwordx4 v[212:215], v153, s[32:35], s62 offen offset:0 sc1
    buffer_load_dwordx4 v[216:219], v154, s[32:35], s62 offen offset:0 sc1
    buffer_load_dwordx4 v[220:223], v155, s[32:35], s62 offen offset:0 sc1
    s_mul_i32 s62, s57, 112
    s_add_u32 s62, s62, s64
    buffer_load_dwordx4 v[224:227], v152, s[32:35], s62 offen offset:0 sc1
    buffer_load_dwordx4 v[228:231], v153, s[32:35], s62 offen offset:0 sc1
    buffer_load_dwordx4 v[232:235], v154, s[32:35], s62 offen offset:0 sc1
    buffer_load_dwordx4 v[236:239], v155, s[32:35], s62 offen offset:0 sc1
    s_mul_i32 s62, s58, 112
    s_add_u32 s62, s62, s64
    buffer_load_dwordx4 v[240:243], v152, s[32:35], s62 offen offset:0 sc1
    buffer_load_dwordx4 v[244:247], v153, s[32:35], s62 offen offset:0 sc1
    buffer_load_dwordx4 v[248:251], v154, s[32:35], s62 offen offset:0 sc1
    buffer_load_dwordx4 v[252:255], v155, s[32:35], s62 offen offset:0 sc1
    s_mul_i32 s62, s59, 112
    s_add_u32 s62, s62, s64
    buffer_load_dwordx4 a[0:3], v152, s[32:35], s62 offen offset:0 sc1
    buffer_load_dwordx4 a[4:7], v153, s[32:35], s62 offen offset:0 sc1
    buffer_load_dwordx4 a[8:11], v154, s[32:35], s62 offen offset:0 sc1
    buffer_load_dwordx4 a[12:15], v155, s[32:35], s62 offen offset:0 sc1
    s_waitcnt vmcnt(25)
    v_mfma_f32_16x16x32_bf16 v[180:183], v[172:175], v[96:99], 0
    v_mfma_f32_16x16x32_bf16 v[180:183], v[172:175], v[100:103], v[180:183]
    v_mfma_f32_16x16x32_bf16 v[180:183], v[172:175], v[104:107], v[180:183]
    v_mfma_f32_16x16x32_bf16 v[180:183], v[172:175], v[108:111], v[180:183]
    s_waitcnt vmcnt(21)
    v_mfma_f32_16x16x32_bf16 v[180:183], v[176:179], v[112:115], v[180:183]
    v_mfma_f32_16x16x32_bf16 v[180:183], v[176:179], v[116:119], v[180:183]
    v_mfma_f32_16x16x32_bf16 v[180:183], v[176:179], v[120:123], v[180:183]
    v_mfma_f32_16x16x32_bf16 v[180:183], v[176:179], v[124:127], v[180:183]
    s_waitcnt vmcnt(17)
    v_mfma_f32_16x16x32_bf16 v[184:187], v[172:175], v[128:131], 0
    v_mfma_f32_16x16x32_bf16 v[184:187], v[172:175], v[132:135], v[184:187]
    v_mfma_f32_16x16x32_bf16 v[184:187], v[172:175], v[136:139], v[184:187]
    v_mfma_f32_16x16x32_bf16 v[184:187], v[172:175], v[140:143], v[184:187]
    s_waitcnt vmcnt(12)
    v_mfma_f32_16x16x32_bf16 v[184:187], v[176:179], v[208:211], v[184:187]
    v_mfma_f32_16x16x32_bf16 v[184:187], v[176:179], v[212:215], v[184:187]
    v_mfma_f32_16x16x32_bf16 v[184:187], v[176:179], v[216:219], v[184:187]
    v_mfma_f32_16x16x32_bf16 v[184:187], v[176:179], v[220:223], v[184:187]
    s_waitcnt vmcnt(8)
    v_mfma_f32_16x16x32_bf16 v[188:191], v[172:175], v[224:227], 0
    v_mfma_f32_16x16x32_bf16 v[188:191], v[172:175], v[228:231], v[188:191]
    v_mfma_f32_16x16x32_bf16 v[188:191], v[172:175], v[232:235], v[188:191]
    v_mfma_f32_16x16x32_bf16 v[188:191], v[172:175], v[236:239], v[188:191]
    s_waitcnt vmcnt(4)
    v_mfma_f32_16x16x32_bf16 v[188:191], v[176:179], v[240:243], v[188:191]
    v_mfma_f32_16x16x32_bf16 v[188:191], v[176:179], v[244:247], v[188:191]
    v_mfma_f32_16x16x32_bf16 v[188:191], v[176:179], v[248:251], v[188:191]
    v_mfma_f32_16x16x32_bf16 v[188:191], v[176:179], v[252:255], v[188:191]
    v_cvt_pk_bf16_f32 v180, v180, v181
    v_cvt_pk_bf16_f32 v181, v182, v183
    buffer_store_dwordx2 v[180:181], v156, s[24:27], s39 offen offset:0
    v_cvt_pk_bf16_f32 v184, v184, v185
    v_cvt_pk_bf16_f32 v185, v186, v187
    buffer_store_dwordx2 v[184:185], v157, s[24:27], s39 offen offset:0
    s_waitcnt vmcnt(2)
    v_mfma_f32_16x16x32_bf16 v[192:195], v[172:175], a[0:3], 0
    v_mfma_f32_16x16x32_bf16 v[192:195], v[172:175], a[4:7], v[192:195]
    v_mfma_f32_16x16x32_bf16 v[192:195], v[172:175], a[8:11], v[192:195]
    v_mfma_f32_16x16x32_bf16 v[192:195], v[172:175], a[12:15], v[192:195]
    v_cvt_pk_bf16_f32 v188, v188, v189
    v_cvt_pk_bf16_f32 v189, v190, v191
    buffer_store_dwordx2 v[188:189], v158, s[24:27], s39 offen offset:0
    s_nop 4
    v_cvt_pk_bf16_f32 v192, v192, v193
    v_cvt_pk_bf16_f32 v193, v194, v195
    buffer_store_dwordx2 v[192:193], v159, s[24:27], s39 offen offset:0
L_tail_end:
L_done:
    s_endpgm
L_unsafe:
    s_cmp_lg_u32 s47, 0
    s_cbranch_scc1 L_safe
    s_mov_b32 s47, 1
    s_waitcnt vmcnt(0) lgkmcnt(0)
    s_nop 7
    s_nop 7
    s_barrier
    s_branch L_restart
L_slow:
    ds_read_b128 a[0:3], v20 offset:0
    ds_read_b128 a[4:7], v20 offset:1024
    ds_read_b128 a[8:11], v20 offset:2048
    ds_read_b128 a[12:15], v20 offset:3072
    ds_read_b128 a[16:19], v20 offset:4096
    ds_read_b128 a[20:23], v20 offset:5120
    ds_read_b128 a[24:27], v20 offset:6144
    ds_read_b128 a[28:31], v20 offset:7168
    s_waitcnt lgkmcnt(0)
    ds_read_b128 a[32:35], v20 offset:8192
    ds_read_b128 a[36:39], v20 offset:9216
    ds_read_b128 a[40:43], v20 offset:10240
    ds_read_b128 a[44:47], v20 offset:11264
    ds_read_b128 a[48:51], v20 offset:12288
    ds_read_b128 a[52:55], v20 offset:13312
    ds_read_b128 a[56:59], v20 offset:14336
    ds_read_b128 a[60:63], v20 offset:15360
    s_waitcnt lgkmcnt(0)
    ds_read_b128 a[64:67], v20 offset:16384
    ds_read_b128 a[68:71], v20 offset:17408
    ds_read_b128 a[72:75], v20 offset:18432
    ds_read_b128 a[76:79], v20 offset:19456
    ds_read_b128 a[80:83], v20 offset:20480
    ds_read_b128 a[84:87], v20 offset:21504
    ds_read_b128 a[88:91], v20 offset:22528
    ds_read_b128 a[92:95], v20 offset:23552
    s_waitcnt lgkmcnt(0)
    ds_read_b128 a[96:99], v20 offset:24576
    ds_read_b128 a[100:103], v20 offset:25600
    ds_read_b128 a[104:107], v20 offset:26624
    ds_read_b128 a[108:111], v20 offset:27648
    ds_read_b128 a[112:115], v20 offset:28672
    ds_read_b128 a[116:119], v20 offset:29696
    ds_read_b128 a[120:123], v20 offset:30720
    ds_read_b128 a[124:127], v20 offset:31744
    s_waitcnt lgkmcnt(0)
    ds_read_b128 a[128:131], v20 offset:32768
    ds_read_b128 a[132:135], v20 offset:33792
    ds_read_b128 a[136:139], v20 offset:34816
    ds_read_b128 a[140:143], v20 offset:35840
    ds_read_b128 a[144:147], v20 offset:36864
    ds_read_b128 a[148:151], v20 offset:37888
    ds_read_b128 a[152:155], v20 offset:38912
    ds_read_b128 a[156:159], v20 offset:39936
    s_waitcnt lgkmcnt(0)
    ds_read_b128 a[160:163], v20 offset:40960
    ds_read_b128 a[164:167], v20 offset:41984
    ds_read_b128 a[168:171], v20 offset:43008
    ds_read_b128 a[172:175], v20 offset:44032
    ds_read_b128 a[176:179], v20 offset:45056
    ds_read_b128 a[180:183], v20 offset:46080
    ds_read_b128 a[184:187], v20 offset:47104
    ds_read_b128 a[188:191], v20 offset:48128
    s_waitcnt lgkmcnt(0)
    ds_read_b128 a[192:195], v20 offset:49152
    ds_read_b128 a[196:199], v20 offset:50176
    ds_read_b128 a[200:203], v20 offset:51200
    ds_read_b128 a[204:207], v20 offset:52224
    ds_read_b128 a[208:211], v20 offset:53248
    ds_read_b128 a[212:215], v20 offset:54272
    ds_read_b128 a[216:219], v20 offset:55296
    ds_read_b128 a[220:223], v20 offset:56320
    s_waitcnt lgkmcnt(0)
    v_and_b32 v160, 15, v0
    v_lshrrev_b32 v161, 4, v0
    v_lshlrev_b32 v160, 9, v160
    v_lshlrev_b32 v161, 4, v161
    v_add_u32 v160, v160, v161
    v_mov_b32 v164, 0xff800000
    v_mov_b32 v165, 0xff800000
    v_mov_b32 v166, 0xff800000
    v_mov_b32 v167, 0xff800000
    v_mov_b32 v168, 0xff800000
    v_mov_b32 v169, 0xff800000
    v_mov_b32 v170, 0xff800000
    s_mov_b32 s61, 0
L_slow_loop:
    s_lshr_b32 s62, s61, 1
    s_lshl_b32 s62, s62, 16
    s_and_b32 s63, s61, 1
    s_lshl_b32 s63, s63, 13
    s_add_u32 s62, s62, s63
    s_add_u32 s62, s62, s41
    buffer_load_dwordx4 v[176:179], v160, s[8:11], s62 offen offset:0
    buffer_load_dwordx4 v[180:183], v160, s[8:11], s62 offen offset:64
    buffer_load_dwordx4 v[184:187], v160, s[8:11], s62 offen offset:128
    buffer_load_dwordx4 v[188:191], v160, s[8:11], s62 offen offset:192
    buffer_load_dwordx4 v[192:195], v160, s[8:11], s62 offen offset:256
    buffer_load_dwordx4 v[196:199], v160, s[8:11], s62 offen offset:320
    buffer_load_dwordx4 v[200:203], v160, s[8:11], s62 offen offset:384
    buffer_load_dwordx4 v[204:207], v160, s[8:11], s62 offen offset:448
    s_waitcnt vmcnt(0)
    v_mfma_f32_16x16x32_bf16 v[60:63], v[176:179], a[0:3], 0
    v_mfma_f32_16x16x32_bf16 v[64:67], v[176:179], a[4:7], 0
    v_mfma_f32_16x16x32_bf16 v[68:71], v[176:179], a[8:11], 0
    v_mfma_f32_16x16x32_bf16 v[72:75], v[176:179], a[12:15], 0
    v_mfma_f32_16x16x32_bf16 v[76:79], v[176:179], a[16:19], 0
    v_mfma_f32_16x16x32_bf16 v[80:83], v[176:179], a[20:23], 0
    v_mfma_f32_16x16x32_bf16 v[84:87], v[176:179], a[24:27], 0
    v_mfma_f32_16x16x32_bf16 v[60:63], v[180:183], a[28:31], v[60:63]
    v_mfma_f32_16x16x32_bf16 v[64:67], v[180:183], a[32:35], v[64:67]
    v_mfma_f32_16x16x32_bf16 v[68:71], v[180:183], a[36:39], v[68:71]
    v_mfma_f32_16x16x32_bf16 v[72:75], v[180:183], a[40:43], v[72:75]
    v_mfma_f32_16x16x32_bf16 v[76:79], v[180:183], a[44:47], v[76:79]
    v_mfma_f32_16x16x32_bf16 v[80:83], v[180:183], a[48:51], v[80:83]
    v_mfma_f32_16x16x32_bf16 v[84:87], v[180:183], a[52:55], v[84:87]
    v_mfma_f32_16x16x32_bf16 v[60:63], v[184:187], a[56:59], v[60:63]
    v_mfma_f32_16x16x32_bf16 v[64:67], v[184:187], a[60:63], v[64:67]
    v_mfma_f32_16x16x32_bf16 v[68:71], v[184:187], a[64:67], v[68:71]
    v_mfma_f32_16x16x32_bf16 v[72:75], v[184:187], a[68:71], v[72:75]
    v_mfma_f32_16x16x32_bf16 v[76:79], v[184:187], a[72:75], v[76:79]
    v_mfma_f32_16x16x32_bf16 v[80:83], v[184:187], a[76:79], v[80:83]
    v_mfma_f32_16x16x32_bf16 v[84:87], v[184:187], a[80:83], v[84:87]
    v_mfma_f32_16x16x32_bf16 v[60:63], v[188:191], a[84:87], v[60:63]
    v_mfma_f32_16x16x32_bf16 v[64:67], v[188:191], a[88:91], v[64:67]
    v_mfma_f32_16x16x32_bf16 v[68:71], v[188:191], a[92:95], v[68:71]
    v_mfma_f32_16x16x32_bf16 v[72:75], v[188:191], a[96:99], v[72:75]
    v_mfma_f32_16x16x32_bf16 v[76:79], v[188:191], a[100:103], v[76:79]
    v_mfma_f32_16x16x32_bf16 v[80:83], v[188:191], a[104:107], v[80:83]
    v_mfma_f32_16x16x32_bf16 v[84:87], v[188:191], a[108:111], v[84:87]
    v_mfma_f32_16x16x32_bf16 v[60:63], v[192:195], a[112:115], v[60:63]
    v_mfma_f32_16x16x32_bf16 v[64:67], v[192:195], a[116:119], v[64:67]
    v_mfma_f32_16x16x32_bf16 v[68:71], v[192:195], a[120:123], v[68:71]
    v_mfma_f32_16x16x32_bf16 v[72:75], v[192:195], a[124:127], v[72:75]
    v_mfma_f32_16x16x32_bf16 v[76:79], v[192:195], a[128:131], v[76:79]
    v_mfma_f32_16x16x32_bf16 v[80:83], v[192:195], a[132:135], v[80:83]
    v_mfma_f32_16x16x32_bf16 v[84:87], v[192:195], a[136:139], v[84:87]
    v_mfma_f32_16x16x32_bf16 v[60:63], v[196:199], a[140:143], v[60:63]
    v_mfma_f32_16x16x32_bf16 v[64:67], v[196:199], a[144:147], v[64:67]
    v_mfma_f32_16x16x32_bf16 v[68:71], v[196:199], a[148:151], v[68:71]
    v_mfma_f32_16x16x32_bf16 v[72:75], v[196:199], a[152:155], v[72:75]
    v_mfma_f32_16x16x32_bf16 v[76:79], v[196:199], a[156:159], v[76:79]
    v_mfma_f32_16x16x32_bf16 v[80:83], v[196:199], a[160:163], v[80:83]
    v_mfma_f32_16x16x32_bf16 v[84:87], v[196:199], a[164:167], v[84:87]
    v_mfma_f32_16x16x32_bf16 v[60:63], v[200:203], a[168:171], v[60:63]
    v_mfma_f32_16x16x32_bf16 v[64:67], v[200:203], a[172:175], v[64:67]
    v_mfma_f32_16x16x32_bf16 v[68:71], v[200:203], a[176:179], v[68:71]
    v_mfma_f32_16x16x32_bf16 v[72:75], v[200:203], a[180:183], v[72:75]
    v_mfma_f32_16x16x32_bf16 v[76:79], v[200:203], a[184:187], v[76:79]
    v_mfma_f32_16x16x32_bf16 v[80:83], v[200:203], a[188:191], v[80:83]
    v_mfma_f32_16x16x32_bf16 v[84:87], v[200:203], a[192:195], v[84:87]
    v_mfma_f32_16x16x32_bf16 v[60:63], v[204:207], a[196:199], v[60:63]
    v_mfma_f32_16x16x32_bf16 v[64:67], v[204:207], a[200:203], v[64:67]
    v_mfma_f32_16x16x32_bf16 v[68:71], v[204:207], a[204:207], v[68:71]
    v_mfma_f32_16x16x32_bf16 v[72:75], v[204:207], a[208:211], v[72:75]
    v_mfma_f32_16x16x32_bf16 v[76:79], v[204:207], a[212:215], v[76:79]
    v_mfma_f32_16x16x32_bf16 v[80:83], v[204:207], a[216:219], v[80:83]
    v_mfma_f32_16x16x32_bf16 v[84:87], v[204:207], a[220:223], v[84:87]
    s_nop 7
    s_nop 7
    v_max3_f32 v164, v164, v60, v61
    v_max3_f32 v164, v164, v62, v63
    v_max3_f32 v165, v165, v64, v65
    v_max3_f32 v165, v165, v66, v67
    v_max3_f32 v166, v166, v68, v69
    v_max3_f32 v166, v166, v70, v71
    v_max3_f32 v167, v167, v72, v73
    v_max3_f32 v167, v167, v74, v75
    v_max3_f32 v168, v168, v76, v77
    v_max3_f32 v168, v168, v78, v79
    v_max3_f32 v169, v169, v80, v81
    v_max3_f32 v169, v169, v82, v83
    v_max3_f32 v170, v170, v84, v85
    v_max3_f32 v170, v170, v86, v87
    s_add_u32 s61, s61, 1
    s_cmp_lt_u32 s61, 8
    s_cbranch_scc1 L_slow_loop
    v_and_b32 v160, 15, v0
    v_lshlrev_b32 v160, 6, v160
    v_add_u32 v160, 156160, v160
    v_lshrrev_b32 v161, 4, v0
    v_lshlrev_b32 v161, 2, v161
    s_lshl_b32 s61, s36, 4
    v_add3_u32 v161, v161, v160, s61
    ds_write_b32 v161, v164 offset:0
    ds_write_b32 v161, v165 offset:1024
    ds_write_b32 v161, v166 offset:2048
    ds_write_b32 v161, v167 offset:3072
    ds_write_b32 v161, v168 offset:4096
    ds_write_b32 v161, v169 offset:5120
    ds_write_b32 v161, v170 offset:6144
    s_waitcnt lgkmcnt(0)
    s_barrier
    ds_read_b128 v[176:179], v160 offset:0
    ds_read_b128 v[180:183], v160 offset:16
    ds_read_b128 v[184:187], v160 offset:32
    ds_read_b128 v[188:191], v160 offset:48
    s_waitcnt lgkmcnt(0)
    v_max3_f32 v163, v176, v177, v178
    v_max3_f32 v163, v163, v179, v180
    v_max3_f32 v163, v163, v181, v182
    v_max3_f32 v163, v163, v183, v184
    v_max3_f32 v163, v163, v185, v186
    v_max3_f32 v163, v163, v187, v188
    v_max3_f32 v163, v163, v189, v190
    v_max_f32 v163, v163, v191
    v_sub_f32 v200, 0, v163
    v_sub_f32 v201, 0, v163
    v_sub_f32 v202, 0, v163
    v_sub_f32 v203, 0, v163
    ds_read_b128 v[176:179], v160 offset:1024
    ds_read_b128 v[180:183], v160 offset:1040
    ds_read_b128 v[184:187], v160 offset:1056
    ds_read_b128 v[188:191], v160 offset:1072
    s_waitcnt lgkmcnt(0)
    v_max3_f32 v163, v176, v177, v178
    v_max3_f32 v163, v163, v179, v180
    v_max3_f32 v163, v163, v181, v182
    v_max3_f32 v163, v163, v183, v184
    v_max3_f32 v163, v163, v185, v186
    v_max3_f32 v163, v163, v187, v188
    v_max3_f32 v163, v163, v189, v190
    v_max_f32 v163, v163, v191
    v_sub_f32 v204, 0, v163
    v_sub_f32 v205, 0, v163
    v_sub_f32 v206, 0, v163
    v_sub_f32 v207, 0, v163
    ds_read_b128 v[176:179], v160 offset:2048
    ds_read_b128 v[180:183], v160 offset:2064
    ds_read_b128 v[184:187], v160 offset:2080
    ds_read_b128 v[188:191], v160 offset:2096
    s_waitcnt lgkmcnt(0)
    v_max3_f32 v163, v176, v177, v178
    v_max3_f32 v163, v163, v179, v180
    v_max3_f32 v163, v163, v181, v182
    v_max3_f32 v163, v163, v183, v184
    v_max3_f32 v163, v163, v185, v186
    v_max3_f32 v163, v163, v187, v188
    v_max3_f32 v163, v163, v189, v190
    v_max_f32 v163, v163, v191
    v_sub_f32 v208, 0, v163
    v_sub_f32 v209, 0, v163
    v_sub_f32 v210, 0, v163
    v_sub_f32 v211, 0, v163
    ds_read_b128 v[176:179], v160 offset:3072
    ds_read_b128 v[180:183], v160 offset:3088
    ds_read_b128 v[184:187], v160 offset:3104
    ds_read_b128 v[188:191], v160 offset:3120
    s_waitcnt lgkmcnt(0)
    v_max3_f32 v163, v176, v177, v178
    v_max3_f32 v163, v163, v179, v180
    v_max3_f32 v163, v163, v181, v182
    v_max3_f32 v163, v163, v183, v184
    v_max3_f32 v163, v163, v185, v186
    v_max3_f32 v163, v163, v187, v188
    v_max3_f32 v163, v163, v189, v190
    v_max_f32 v163, v163, v191
    v_sub_f32 v212, 0, v163
    v_sub_f32 v213, 0, v163
    v_sub_f32 v214, 0, v163
    v_sub_f32 v215, 0, v163
    ds_read_b128 v[176:179], v160 offset:4096
    ds_read_b128 v[180:183], v160 offset:4112
    ds_read_b128 v[184:187], v160 offset:4128
    ds_read_b128 v[188:191], v160 offset:4144
    s_waitcnt lgkmcnt(0)
    v_max3_f32 v163, v176, v177, v178
    v_max3_f32 v163, v163, v179, v180
    v_max3_f32 v163, v163, v181, v182
    v_max3_f32 v163, v163, v183, v184
    v_max3_f32 v163, v163, v185, v186
    v_max3_f32 v163, v163, v187, v188
    v_max3_f32 v163, v163, v189, v190
    v_max_f32 v163, v163, v191
    v_sub_f32 v216, 0, v163
    v_sub_f32 v217, 0, v163
    v_sub_f32 v218, 0, v163
    v_sub_f32 v219, 0, v163
    ds_read_b128 v[176:179], v160 offset:5120
    ds_read_b128 v[180:183], v160 offset:5136
    ds_read_b128 v[184:187], v160 offset:5152
    ds_read_b128 v[188:191], v160 offset:5168
    s_waitcnt lgkmcnt(0)
    v_max3_f32 v163, v176, v177, v178
    v_max3_f32 v163, v163, v179, v180
    v_max3_f32 v163, v163, v181, v182
    v_max3_f32 v163, v163, v183, v184
    v_max3_f32 v163, v163, v185, v186
    v_max3_f32 v163, v163, v187, v188
    v_max3_f32 v163, v163, v189, v190
    v_max_f32 v163, v163, v191
    v_sub_f32 v220, 0, v163
    v_sub_f32 v221, 0, v163
    v_sub_f32 v222, 0, v163
    v_sub_f32 v223, 0, v163
    ds_read_b128 v[176:179], v160 offset:6144
    ds_read_b128 v[180:183], v160 offset:6160
    ds_read_b128 v[184:187], v160 offset:6176
    ds_read_b128 v[188:191], v160 offset:6192
    s_waitcnt lgkmcnt(0)
    v_max3_f32 v163, v176, v177, v178
    v_max3_f32 v163, v163, v179, v180
    v_max3_f32 v163, v163, v181, v182
    v_max3_f32 v163, v163, v183, v184
    v_max3_f32 v163, v163, v185, v186
    v_max3_f32 v163, v163, v187, v188
    v_max3_f32 v163, v163, v189, v190
    v_max_f32 v163, v163, v191
    v_sub_f32 v224, 0, v163
    v_sub_f32 v225, 0, v163
    v_sub_f32 v226, 0, v163
    v_sub_f32 v227, 0, v163
    s_nop 1
    s_barrier
    s_branch L_fast
L_census:
    s_mov_b32 s98, 0x40000
L_census_loop:
    buffer_load_dword v196, off, s[28:31], s52 sc1
    s_sub_u32 s98, s98, 1
    s_waitcnt vmcnt(0)
    v_readfirstlane_b32 s60, v196
    s_cmp_eq_u32 s98, 0
    s_cbranch_scc1 L_census_ok
    s_cmp_eq_u32 s60, 1
    s_cbranch_scc1 L_census_ok
    s_sleep 8
    s_branch L_census_loop
.section .rodata,"a"
.p2align 6
.amdhsa_kernel standalone__gqa_block_cached__near_ridge_kernel
  .amdhsa_next_free_vgpr 512
  .amdhsa_next_free_sgpr 102
  .amdhsa_accum_offset 256
  .amdhsa_group_segment_fixed_size 0
  .amdhsa_kernarg_size 64
  .amdhsa_user_sgpr_count 2
  .amdhsa_user_sgpr_kernarg_segment_ptr 1
  .amdhsa_system_sgpr_workgroup_id_x 1
.end_amdhsa_kernel
```
